```python
import torch

def _softmax(x, axis=-1):
    return torch.softmax(x, dim=axis)
def _gelu(x):
    return torch.nn.functional.gelu(x, approximate="tanh")
def _silu(x):
    return torch.nn.functional.silu(x)
def _sigmoid(x):
    return torch.sigmoid(x)
def _layernorm(x, axis=-1, eps=1e-5):
    m = x.mean(dim=axis, keepdim=True)
    v = x.var(dim=axis, keepdim=True, unbiased=False)
    return (x - m) / torch.sqrt(v + eps)
def _scatter_add(tgt, idx, src, axis=0):
    return tgt.clone().index_add_(axis, idx, src)
def _segment_sum(src, seg, n):
    out = torch.zeros((n,) + src.shape[1:], dtype=src.dtype)
    return out.index_add_(0, seg, src)
def _pad(x, pw):
    flat = tuple(v for pair in reversed(pw) for v in pair)
    return torch.nn.functional.pad(x, flat)

kernel_name = 'recurrent_scan__spectral_fnet__mixer_token_mlp__prompt'

def setup_inputs():

    _w = (lambda a: (lambda t: t.to(torch.bfloat16) if t.is_floating_point() else t)(torch.as_tensor(a)))
    def _A_setup():
        B, S, D = 1, 2048, 512
        ns = torch.arange(S)[:, None] * torch.arange(S)[None, :]
        nd = torch.arange(D)[:, None] * torch.arange(D)[None, :]
        Ws_re = torch.cos(-2.0 * torch.pi * ns / S).to(float)
        Ws_im = torch.sin(-2.0 * torch.pi * ns / S).to(float)
        Wd_re = torch.cos(-2.0 * torch.pi * nd / D).to(float)
        Wd_im = torch.sin(-2.0 * torch.pi * nd / D).to(float)
        return {
            "x": _w((lambda *s: torch.randn(*s, dtype=torch.bfloat16) * 0.05)(B, S, D)),
            "dft_seq_re": _w(Ws_re),
            "dft_seq_im": _w(Ws_im),
            "dft_hid_re": _w(Wd_re),
            "dft_hid_im": _w(Wd_im),
        }
    _A_in = _A_setup()

    def _B_setup():
        B, S, D, F = 1, 2048, 512, 1792
        return {
            "x": _w((lambda *s: torch.randn(*s, dtype=torch.bfloat16) * 0.05)(B, S, D)),
            "w1": _w((lambda *s: torch.randn(*s, dtype=torch.bfloat16) * 0.2)(S, F) * (S ** -0.5)),
            "b1": _w((lambda *s: torch.randn(*s, dtype=torch.bfloat16) * 3.2)(F) * 0.02),
            "w2": _w((lambda *s: torch.randn(*s, dtype=torch.bfloat16) * 0.05)(F, S) * (F ** -0.5)),
            "b2": _w((lambda *s: torch.randn(*s, dtype=torch.bfloat16) * 0.05)(S) * 0.02),
        }
    _B_in = _B_setup()

    return {
        "A_x": _A_in["x"],
        "A_dft_seq_re": _A_in["dft_seq_re"],
        "A_dft_seq_im": _A_in["dft_seq_im"],
        "A_dft_hid_re": _A_in["dft_hid_re"],
        "A_dft_hid_im": _A_in["dft_hid_im"],
        "B_x": _B_in["x"],
        "B_w1": _B_in["w1"],
        "B_b1": _B_in["b1"],
        "B_w2": _B_in["w2"],
        "B_b2": _B_in["b2"],
    }

def reference(A_x, A_dft_seq_re, A_dft_seq_im, A_dft_hid_re, A_dft_hid_im, B_x, B_w1, B_b1, B_w2, B_b2):
    def _A_ref(x, dft_seq_re, dft_seq_im, dft_hid_re, dft_hid_im):
        a = torch.einsum("bsd,ed->bse", x, dft_hid_re)
        b = torch.einsum("bsd,ed->bse", x, dft_hid_im)
        y = torch.einsum("ts,bse->bte", dft_seq_re, a) - torch.einsum("ts,bse->bte", dft_seq_im, b)
        return y

    def _B_ref(x, w1, b1, w2, b2):
        B, S, D = x.shape
        h = _layernorm(x, axis=-1)
        u = torch.einsum("bsd,sf->bdf", h, w1) + b1
        u = _gelu(u)
        y = torch.einsum("bdf,fs->bds", u, w2) + b2
        return (lambda x, *d: x.permute(*d))(y, 0, 2, 1)

    x = A_x
    xn = _layernorm(x, axis=-1)
    s = _A_ref(xn, A_dft_seq_re, A_dft_seq_im, A_dft_hid_re, A_dft_hid_im)
    g = _silu(_B_ref(xn, B_w1, B_b1, B_w2, B_b2))
    return x + s * g
```

```asm
; @launch grid=(256,1,1) block=(256,1,1) lds=163840
.amdgcn_target "amdgcn-amd-amdhsa--gfx950"
.text
.globl recurrent_scan__spectral_fnet__mixer_token_mlp__prompt_kernel
.p2align 8
.type recurrent_scan__spectral_fnet__mixer_token_mlp__prompt_kernel,@function
recurrent_scan__spectral_fnet__mixer_token_mlp__prompt_kernel:
  s_cmp_ge_u32 s2, 256
  s_cbranch_scc1 L_end
  s_load_dwordx2 s[4:5], s[0:1], 0
  s_load_dwordx2 s[8:9], s[0:1], 48
  s_load_dwordx2 s[12:13], s[0:1], 64
  s_load_dwordx2 s[16:17], s[0:1], 96
  s_load_dwordx2 s[24:25], s[0:1], 56
  s_load_dwordx2 s[28:29], s[0:1], 72
  s_load_dwordx2 s[20:21], s[0:1], 80
  s_getpc_b64 s[50:51]
  v_lshrrev_b32 v11, 5, v0
  s_and_b32 s52, s2, 0xf8
  v_add_lshl_u32 v11, v11, s52, 7
  v_min_u32 v11, L_end-recurrent_scan__spectral_fnet__mixer_token_mlp__prompt_kernel-128, v11
  v_mov_b32 v13, s51
  v_add_co_u32 v12, vcc, s50, v11
  s_nop 1
  v_addc_co_u32 v13, vcc, 0, v13, vcc
  global_load_dword v255, v[12:13], off
  v_lshrrev_b32 v11, 6, v0
  v_and_b32 v0, 63, v0
  v_readfirstlane_b32 s3, v11
  v_lshlrev_b32 v7, 4, v0
  v_and_b32 v14, 32, v0
  v_lshl_add_u32 v14, v14, 4, v7
  s_mov_b32 s6, 2097152
  s_mov_b32 s7, 0x20000
  s_mov_b32 s10, 7340032
  s_mov_b32 s11, 0x20000
  s_lshl_b32 s52, s2, 13
  s_lshl_b32 s53, s3, 11
  s_add_u32 s77, s52, s53
  s_and_b32 s33, s2, 7
  s_lshr_b32 s34, s2, 3
  s_mul_i32 s50, s34, 37
  s_lshr_b32 s50, s50, 8
  s_mul_i32 s51, s50, 7
  s_sub_u32 s51, s34, s51
  s_lshr_b32 s52, s33, 1
  s_and_b32 s53, s33, 1
  s_mul_i32 s35, s52, 7
  s_add_u32 s35, s35, s51
  s_lshl2_add_u32 s36, s53, s50
  s_mul_i32 s63, s50, 0
  s_lshl_b32 s72, s51, 2
  s_and_b32 s50, s34, 7
  s_mul_i32 s73, s50, 7
  s_lshr_b32 s73, s73, 2
  s_lshl_b32 s73, s73, 1
  s_lshr_b32 s51, s34, 3
  s_lshl3_add_u32 s37, s52, s50
  s_lshl2_add_u32 s38, s53, s51
  s_mul_i32 s64, s51, 0
  s_lshl_b32 s47, s3, 15
  s_add_u32 s47, s47, 32768
  s_lshr_b32 s67, s3, 1
  s_and_b32 s68, s3, 1
  s_waitcnt lgkmcnt(0)
  buffer_load_dwordx4 v[16:19], v14, s[4:7], s77 offen
  buffer_load_dwordx4 v[20:23], v14, s[4:7], s77 offen offset:512
  s_mov_b32 s59, 7405568
  s_load_dword s32, s[16:17], s59
  s_lshr_b32 s50, s33, 1
  s_mul_i32 s50, s50, 7
  s_lshr_b32 s51, s8, 7
  s_add_u32 s52, s51, s50
  s_sub_u32 s52, 3, s52
  s_and_b32 s52, s52, 3
  s_cmp_lt_u32 s52, 3
  s_cselect_b32 s53, 512, 0
  s_add_u32 s50, s50, s52
  s_lshl_b32 s50, s50, 7
  s_mul_i32 s51, s3, 1835008
  s_mul_i32 s52, s34, 28672
  s_add_u32 s50, s50, s51
  s_add_u32 s50, s50, s52
  s_add_u32 s50, s50, 917504
  v_and_b32 v11, 15, v0
  v_min_u32 v11, 7, v11
  v_mul_u32_u24 v11, 3584, v11
  v_bfe_i32 v12, v0, 4, 1
  v_and_b32 v12, s53, v12
  v_add_u32 v11, v11, v12
  buffer_load_dword v255, v11, s[8:11], s50 offen
  s_lshr_b32 s50, s8, 7
  s_add_u32 s50, s50, s35
  s_and_b32 s50, s50, 3
  s_cmp_eq_u32 s50, 3
  s_cselect_b32 s63, s63, 0
  s_lshr_b32 s50, s12, 7
  s_add_u32 s50, s50, s37
  s_and_b32 s50, s50, 7
  s_cmp_eq_u32 s50, 3
  s_cselect_b32 s64, s64, 0
  s_and_b32 s50, s36, 3
  s_mov_b32 s75, 0x76532140
  s_cmp_eq_u32 s50, 1
  s_cselect_b32 s75, 0x76403521, s75
  s_cmp_eq_u32 s50, 2
  s_cselect_b32 s75, 0x75416032, s75
  s_cmp_eq_u32 s50, 3
  s_cselect_b32 s75, 0x65472103, s75
  s_bitcmp1_b32 s36, 2
  s_cselect_b32 s50, 0x44444444, 0
  s_xor_b32 s75, s75, s50
  s_and_b32 s63, s75, 7
  s_lshl_b32 s63, s63, 2
  s_cmp_lt_u32 s34, 28
  s_cbranch_scc1 L1_gemm_stream
  s_mul_i32 s41, s3, 1835008
  s_lshl_b32 s50, s37, 7
  s_add_u32 s41, s41, s50
  s_mov_b32 s43, 65536
  s_add_u32 s42, s41, 1835008
  s_mov_b32 s40, 0
  v_mov_b32 v12, 0
  s_mov_b32 s50, 7340032
  s_mov_b32 s51, 7340032
  s_mov_b32 s52, 0
  s_mov_b32 s56, 4096
  s_mov_b32 s57, 512
  s_lshl_b32 s58, s68, 6
  s_branch L2_stream_done
L1_gemm_stream:
  s_mul_i32 s41, s3, 1835008
  s_lshl_b32 s50, s35, 7
  s_add_u32 s41, s41, s50
  s_mov_b32 s43, 57344
  s_add_u32 s42, s41, 1835008
  s_mul_i32 s50, s63, 57344
  s_add_u32 s40, s41, s50
  s_mov_b32 s56, 3584
  s_mov_b32 s57, 1024
  s_lshl_b32 s58, s3, 5
  s_lshr_b32 s51, s8, 7
  s_add_u32 s51, s51, s35
  s_and_b32 s51, s51, 3
  s_cmp_eq_u32 s51, 3
  s_cselect_b32 s51, 32, 64
  s_mul_i32 s50, s36, s51
  s_mul_i32 s50, s50, 3584
  s_add_u32 s50, s50, s41
  s_sub_u32 s51, s51, 1
  s_max_i32 s51, s51, 0
  v_min_u32 v12, s51, v0
  v_mul_u32_u24 v12, 3584, v12
  s_mov_b32 s51, 7340032
  s_mov_b32 s52, 7340032
L2_stream_done:
  s_mov_b32 s10, s52
  v_lshrrev_b32 v11, 3, v0
  v_mul_lo_u32 v1, s56, v11
  v_lshlrev_b32 v11, 1, v11
  v_and_b32 v11, 4, v11
  v_xor_b32 v11, v11, v0
  v_and_b32 v11, 7, v11
  v_lshl_add_u32 v1, v11, 4, v1
  s_lshl_b32 s50, s56, 3
  s_sub_u32 s50, s50, 1024
  v_add_u32 v2, s50, v1
  s_mov_b32 m0, s47
  s_nop 0
  buffer_load_dwordx4 v1, s[8:11], s40 offen lds
  buffer_load_dwordx4 v2, s[8:11], s40 offen offset:1024 lds
  s_add_u32 s40, s40, s43
  s_add_u32 m0, s47, 2048
  s_nop 0
  buffer_load_dwordx4 v1, s[8:11], s40 offen lds
  buffer_load_dwordx4 v2, s[8:11], s40 offen offset:1024 lds
  s_add_u32 s40, s40, s43
  s_add_u32 m0, s47, 4096
  s_nop 0
  buffer_load_dwordx4 v1, s[8:11], s40 offen lds
  buffer_load_dwordx4 v2, s[8:11], s40 offen offset:1024 lds
  s_add_u32 s40, s40, s43
  s_add_u32 m0, s47, 6144
  s_nop 0
  buffer_load_dwordx4 v1, s[8:11], s40 offen lds
  buffer_load_dwordx4 v2, s[8:11], s40 offen offset:1024 lds
  s_bfe_u32 s71, s75, 196612
  s_mul_i32 s71, s71, 229376
  s_add_u32 s40, s41, s71
  s_mov_b32 s18, 10485760
  s_mov_b32 s19, 0x20000
  s_mov_b32 s14, 7340032
  s_mov_b32 s15, 0x20000
  s_mov_b32 s26, 3584
  s_mov_b32 s27, 0x20000
  s_mov_b32 s30, 4096
  s_mov_b32 s31, 0x20000
  s_mov_b32 s22, 2097152
  s_mov_b32 s23, 0x20000
  s_lshl_b32 s39, s33, 2
  s_add_u32 s39, s39, s34
  s_sub_u32 s39, s39, 28
  s_mov_b32 s48, 1024
  s_mov_b32 s69, 2048
  s_mov_b32 s49, 0xffff0000
  s_mov_b32 s66, 0x3f803f80
  s_mov_b32 s62, 0
  s_mov_b32 s101, 10485760
  s_mov_b32 s60, 0
  s_mov_b32 s61, 1
  v_bfe_u32 v11, v0, 2, 2
  v_lshlrev_b32 v3, 7, v11
  v_lshrrev_b32 v12, 5, v0
  v_mul_lo_u32 v12, s57, v12
  v_add_u32 v3, v3, v12
  v_lshlrev_b32 v11, 5, v11
  v_and_b32 v11, 64, v11
  v_lshlrev_b32 v12, 1, v0
  v_and_b32 v12, 32, v12
  v_and_b32 v13, 3, v0
  v_lshlrev_b32 v13, 3, v13
  v_or3_b32 v11, v11, v12, v13
  v_xor_b32 v11, s58, v11
  v_add3_u32 v3, v3, v11, s47
  v_xor_b32 v4, 64, v3
  v_lshrrev_b32 v11, 5, v0
  v_and_b32 v12, 31, v0
  v_lshlrev_b32 v12, 4, v12
  v_lshl_add_u32 v110, v11, 17, v12
  v_mul_u32_u24 v13, 1088, v11
  s_mul_i32 s50, s3, 2176
  v_add3_u32 v128, v13, v12, s50
  s_lshl_b32 s50, s3, 11
  s_add_u32 s51, s50, 8704
  v_add_u32 v129, s51, v14
  v_lshl_add_u32 v131, v0, 3, s51
  v_bfe_u32 v12, v0, 2, 2
  v_mul_u32_u24 v130, 1088, v12
  v_lshrrev_b32 v12, 4, v0
  v_lshl_add_u32 v130, v12, 5, v130
  v_and_b32 v13, 3, v0
  v_lshl_add_u32 v130, v13, 3, v130
  s_lshl_b32 s51, s3, 8
  v_add_u32 v130, s51, v130
  s_add_u32 s51, s50, 16896
  v_and_b32 v11, 15, v0
  v_lshl_add_u32 v132, v11, 3, s51
  v_lshrrev_b32 v13, 1, v12
  v_lshl_add_u32 v132, v13, 2, v132
  v_and_b32 v13, 1, v12
  v_lshl_add_u32 v132, v13, 10, v132
  s_lshl_b32 s51, s3, 9
  s_add_u32 s51, s51, 16896
  v_lshl_add_u32 v133, v0, 2, s51
  s_lshl_b32 s50, s3, 8
  s_add_u32 s50, s50, s2
  s_mul_i32 s50, s50, 16
  s_add_u32 s98, s50, 8388608
  s_add_u32 s99, s50, 8912896
  s_lshl_b32 s76, s3, 19
  s_lshl_b32 s50, s2, 9
  s_add_u32 s76, s76, s50
  s_add_u32 s72, s76, 262144
  s_add_u32 s77, s77, 2097152
  v_mov_b32 v102, 0x3b000000
  s_waitcnt vmcnt(9)
  v_dot2_f32_bf16 v96, v16, s66, 0
  v_dot2_f32_bf16 v96, v17, s66, v96
  v_dot2_f32_bf16 v96, v18, s66, v96
  v_dot2_f32_bf16 v96, v19, s66, v96
  v_dot2_f32_bf16 v96, v20, s66, v96
  v_dot2_f32_bf16 v96, v21, s66, v96
  v_dot2_f32_bf16 v96, v22, s66, v96
  v_dot2_f32_bf16 v96, v23, s66, v96
  v_lshlrev_b32 v24, 16, v16
  v_and_b32 v25, s49, v16
  v_lshlrev_b32 v26, 16, v17
  v_add_f32_dpp v96, v96, v96 quad_perm:[1,0,3,2] row_mask:0xf bank_mask:0xf
  v_and_b32 v27, s49, v17
  v_lshlrev_b32 v28, 16, v18
  v_add_f32_dpp v96, v96, v96 quad_perm:[2,3,0,1] row_mask:0xf bank_mask:0xf
  v_and_b32 v29, s49, v18
  v_lshlrev_b32 v30, 16, v19
  v_add_f32_dpp v96, v96, v96 row_half_mirror row_mask:0xf bank_mask:0xf
  v_and_b32 v31, s49, v19
  v_lshlrev_b32 v32, 16, v20
  v_add_f32_dpp v96, v96, v96 row_mirror row_mask:0xf bank_mask:0xf
  v_and_b32 v33, s49, v20
  v_lshlrev_b32 v34, 16, v21
  v_mov_b32 v98, v96
  v_and_b32 v35, s49, v21
  v_lshlrev_b32 v36, 16, v22
  v_permlane16_swap_b32 v96, v98
  v_add_f32 v96, v96, v98
  v_mul_f32 v100, 0x3b000000, v96
  v_and_b32 v37, s49, v22
  v_lshlrev_b32 v38, 16, v23
  v_and_b32 v39, s49, v23
  v_pk_add_f32 v[24:25], v[24:25], v[100:101] op_sel:[0,0] op_sel_hi:[1,0] neg_lo:[0,1] neg_hi:[0,1]
  v_pk_add_f32 v[26:27], v[26:27], v[100:101] op_sel:[0,0] op_sel_hi:[1,0] neg_lo:[0,1] neg_hi:[0,1]
  v_pk_add_f32 v[28:29], v[28:29], v[100:101] op_sel:[0,0] op_sel_hi:[1,0] neg_lo:[0,1] neg_hi:[0,1]
  v_pk_add_f32 v[30:31], v[30:31], v[100:101] op_sel:[0,0] op_sel_hi:[1,0] neg_lo:[0,1] neg_hi:[0,1]
  v_pk_add_f32 v[32:33], v[32:33], v[100:101] op_sel:[0,0] op_sel_hi:[1,0] neg_lo:[0,1] neg_hi:[0,1]
  v_pk_add_f32 v[34:35], v[34:35], v[100:101] op_sel:[0,0] op_sel_hi:[1,0] neg_lo:[0,1] neg_hi:[0,1]
  v_pk_add_f32 v[36:37], v[36:37], v[100:101] op_sel:[0,0] op_sel_hi:[1,0] neg_lo:[0,1] neg_hi:[0,1]
  v_pk_add_f32 v[38:39], v[38:39], v[100:101] op_sel:[0,0] op_sel_hi:[1,0] neg_lo:[0,1] neg_hi:[0,1]
  v_pk_mul_f32 v[106:107], v[24:25], v[24:25]
  v_pk_mul_f32 v[108:109], v[26:27], v[26:27]
  v_pk_fma_f32 v[106:107], v[28:29], v[28:29], v[106:107]
  v_pk_fma_f32 v[108:109], v[30:31], v[30:31], v[108:109]
  v_pk_fma_f32 v[106:107], v[32:33], v[32:33], v[106:107]
  v_pk_fma_f32 v[108:109], v[34:35], v[34:35], v[108:109]
  v_pk_fma_f32 v[106:107], v[36:37], v[36:37], v[106:107]
  v_pk_fma_f32 v[108:109], v[38:39], v[38:39], v[108:109]
  v_pk_add_f32 v[106:107], v[106:107], v[108:109]
  v_add_f32 v97, v106, v107
  s_nop 1
  v_add_f32_dpp v97, v97, v97 quad_perm:[1,0,3,2] row_mask:0xf bank_mask:0xf
  v_and_b32 v216, 15, v0
  v_lshrrev_b32 v217, 4, v0
  v_add_f32_dpp v97, v97, v97 quad_perm:[2,3,0,1] row_mask:0xf bank_mask:0xf
  v_lshlrev_b32 v217, 2, v217
  v_cvt_f32_u32 v218, v216
  v_add_f32_dpp v97, v97, v97 row_half_mirror row_mask:0xf bank_mask:0xf
  v_cvt_f32_u32 v217, v217
  v_mul_f32 v219, 0xbd000000, v218
  v_add_f32_dpp v97, v97, v97 row_mirror row_mask:0xf bank_mask:0xf
  v_mul_f32 v220, v219, v217
  v_fmamk_f32 v223, v219, 0x3f800000, v220
  v_mov_b32 v98, v97
  v_cos_f32 v224, v220
  v_sin_f32 v226, v220
  v_permlane16_swap_b32 v97, v98
  v_add_f32 v97, v97, v98
  v_fmaak_f32 v104, v97, v102, 0x3727c5ac
  v_rsq_f32 v104, v104
  v_cos_f32 v225, v223
  v_sin_f32 v227, v223
  v_cvt_pk_f16_f32 v40, v224, v225
  v_cvt_pk_f16_f32 v48, v226, v227
  v_pk_mul_f32 v[24:25], v[24:25], v[104:105] op_sel:[0,0] op_sel_hi:[1,0]
  v_pk_mul_f32 v[26:27], v[26:27], v[104:105] op_sel:[0,0] op_sel_hi:[1,0]
  v_pk_mul_f32 v[28:29], v[28:29], v[104:105] op_sel:[0,0] op_sel_hi:[1,0]
  v_pk_mul_f32 v[30:31], v[30:31], v[104:105] op_sel:[0,0] op_sel_hi:[1,0]
  v_pk_mul_f32 v[32:33], v[32:33], v[104:105] op_sel:[0,0] op_sel_hi:[1,0]
  v_pk_mul_f32 v[34:35], v[34:35], v[104:105] op_sel:[0,0] op_sel_hi:[1,0]
  v_pk_mul_f32 v[36:37], v[36:37], v[104:105] op_sel:[0,0] op_sel_hi:[1,0]
  v_pk_mul_f32 v[38:39], v[38:39], v[104:105] op_sel:[0,0] op_sel_hi:[1,0]
  v_pk_mul_f32 v[106:107], v[24:25], v[24:25]
  v_pk_add_f32 v[112:113], v[24:25], v[26:27]
  v_pk_mul_f32 v[108:109], v[26:27], v[26:27]
  v_pk_add_f32 v[114:115], v[28:29], v[30:31]
  v_pk_fma_f32 v[106:107], v[28:29], v[28:29], v[106:107]
  v_pk_add_f32 v[116:117], v[32:33], v[34:35]
  v_pk_fma_f32 v[108:109], v[30:31], v[30:31], v[108:109]
  v_pk_add_f32 v[118:119], v[36:37], v[38:39]
  v_pk_fma_f32 v[106:107], v[32:33], v[32:33], v[106:107]
  v_pk_add_f32 v[112:113], v[112:113], v[114:115]
  v_pk_fma_f32 v[108:109], v[34:35], v[34:35], v[108:109]
  v_pk_add_f32 v[116:117], v[116:117], v[118:119]
  v_pk_fma_f32 v[106:107], v[36:37], v[36:37], v[106:107]
  v_pk_add_f32 v[112:113], v[112:113], v[116:117]
  v_pk_fma_f32 v[108:109], v[38:39], v[38:39], v[108:109]
  v_add_f32 v96, v112, v113
  v_pk_add_f32 v[106:107], v[106:107], v[108:109]
  v_cvt_pk_f16_f32 v120, v24, v25
  v_add_f32 v97, v106, v107
  v_cvt_pk_f16_f32 v121, v26, v27
  v_cvt_pk_f16_f32 v122, v28, v29
  v_add_f32_dpp v96, v96, v96 quad_perm:[1,0,3,2] row_mask:0xf bank_mask:0xf
  v_add_f32_dpp v97, v97, v97 quad_perm:[1,0,3,2] row_mask:0xf bank_mask:0xf
  v_cvt_pk_f16_f32 v123, v30, v31
  v_add_f32_dpp v96, v96, v96 quad_perm:[2,3,0,1] row_mask:0xf bank_mask:0xf
  v_add_f32_dpp v97, v97, v97 quad_perm:[2,3,0,1] row_mask:0xf bank_mask:0xf
  v_cvt_pk_f16_f32 v124, v32, v33
  v_add_f32_dpp v96, v96, v96 row_half_mirror row_mask:0xf bank_mask:0xf
  v_add_f32_dpp v97, v97, v97 row_half_mirror row_mask:0xf bank_mask:0xf
  v_cvt_pk_f16_f32 v125, v34, v35
  v_add_f32_dpp v96, v96, v96 row_mirror row_mask:0xf bank_mask:0xf
  v_add_f32_dpp v97, v97, v97 row_mirror row_mask:0xf bank_mask:0xf
  v_cvt_pk_f16_f32 v126, v36, v37
  v_mov_b32 v98, v96
  v_mov_b32 v99, v97
  v_cvt_pk_f16_f32 v127, v38, v39
  v_permlane16_swap_b32 v96, v98
  v_permlane16_swap_b32 v97, v99
  v_add_f32 v96, v96, v98
  v_add_f32 v97, v97, v99
  v_mul_f32 v100, 0x3b000000, v96
  v_fmaak_f32 v104, v97, v102, 0x3727c5ac
  v_fma_f32 v104, -v100, v100, v104
  v_rsq_f32 v104, v104
  s_nop 0
  v_mul_f32 v105, -v100, v104
  v_pk_fma_f32 v[24:25], v[24:25], v[104:105], v[104:105] op_sel:[0,0,1] op_sel_hi:[1,0,1]
  v_pk_fma_f32 v[26:27], v[26:27], v[104:105], v[104:105] op_sel:[0,0,1] op_sel_hi:[1,0,1]
  v_pk_fma_f32 v[28:29], v[28:29], v[104:105], v[104:105] op_sel:[0,0,1] op_sel_hi:[1,0,1]
  v_pk_fma_f32 v[30:31], v[30:31], v[104:105], v[104:105] op_sel:[0,0,1] op_sel_hi:[1,0,1]
  v_pk_fma_f32 v[32:33], v[32:33], v[104:105], v[104:105] op_sel:[0,0,1] op_sel_hi:[1,0,1]
  v_pk_fma_f32 v[34:35], v[34:35], v[104:105], v[104:105] op_sel:[0,0,1] op_sel_hi:[1,0,1]
  v_pk_fma_f32 v[36:37], v[36:37], v[104:105], v[104:105] op_sel:[0,0,1] op_sel_hi:[1,0,1]
  v_pk_fma_f32 v[38:39], v[38:39], v[104:105], v[104:105] op_sel:[0,0,1] op_sel_hi:[1,0,1]
  v_cvt_pk_bf16_f32 v16, v24, v25
  v_cvt_pk_bf16_f32 v17, v26, v27
  v_cvt_pk_bf16_f32 v18, v28, v29
  v_cvt_pk_bf16_f32 v19, v30, v31
  v_cvt_pk_bf16_f32 v20, v32, v33
  v_cvt_pk_bf16_f32 v21, v34, v35
  v_cvt_pk_bf16_f32 v22, v36, v37
  v_cvt_pk_bf16_f32 v23, v38, v39
  ds_write_b128 v128, v[16:19] offset:0
  ds_write_b128 v128, v[20:23] offset:512
  ds_write_b128 v129, v[120:123] offset:0
  ds_write_b128 v129, v[124:127] offset:512
  s_waitcnt lgkmcnt(0)
  s_barrier
  s_mul_i32 s32, s32, 0x9e3779b1
  s_add_u32 s32, s32, 0x7f4a7c15
  ds_read_b64_tr_b16 v[16:17], v130 offset:0
  ds_read_b64_tr_b16 v[18:19], v130 offset:4352
  ds_read_b64_tr_b16 v[20:21], v130 offset:128
  ds_read_b64_tr_b16 v[22:23], v130 offset:4480
  ds_read_b64_tr_b16 v[24:25], v131 offset:0
  ds_read_b64_tr_b16 v[26:27], v131 offset:512
  ds_read_b64_tr_b16 v[28:29], v131 offset:1024
  ds_read_b64_tr_b16 v[30:31], v131 offset:1536
  s_waitcnt lgkmcnt(6)
  buffer_store_dwordx4 v[16:19], v110, s[16:19], s76 offen sc1
  s_waitcnt lgkmcnt(4)
  buffer_store_dwordx4 v[20:23], v110, s[16:19], s72 offen sc1
  s_cmp_ge_u32 s34, 28
  s_cbranch_scc1 L_fft
  v_fmamk_f32 v222, v219, 0x40000000, v220
  v_fmamk_f32 v223, v219, 0x40400000, v220
  v_cos_f32 v224, v222
  v_sin_f32 v226, v222
  v_cos_f32 v225, v223
  v_sin_f32 v227, v223
  v_cvt_pk_f16_f32 v41, v224, v225
  v_cvt_pk_f16_f32 v49, v226, v227
  v_fmamk_f32 v222, v219, 0x41800000, v220
  v_fmamk_f32 v223, v219, 0x41880000, v220
  v_cos_f32 v224, v222
  v_sin_f32 v226, v222
  v_cos_f32 v225, v223
  v_sin_f32 v227, v223
  v_cvt_pk_f16_f32 v42, v224, v225
  v_cvt_pk_f16_f32 v50, v226, v227
  s_add_u32 m0, s47, 8192
  s_nop 0
  buffer_load_dwordx4 v1, s[8:11], s40 offen lds
  buffer_load_dwordx4 v2, s[8:11], s40 offen offset:1024 lds
  s_add_u32 s40, s40, s43
  v_fmamk_f32 v222, v219, 0x41900000, v220
  v_fmamk_f32 v223, v219, 0x41980000, v220
  v_cos_f32 v224, v222
  v_sin_f32 v226, v222
  v_cos_f32 v225, v223
  v_sin_f32 v227, v223
  v_cvt_pk_f16_f32 v43, v224, v225
  v_cvt_pk_f16_f32 v51, v226, v227
  v_mul_f32 v219, 0x3b000000, v218
  v_mul_f32 v220, v219, v217
  v_cos_f32 v56, v220
  v_sin_f32 v64, v220
  v_add_f32 v220, v220, v219
  v_cos_f32 v57, v220
  v_sin_f32 v65, v220
  v_add_f32 v220, v220, v219
  s_add_u32 m0, s47, 10240
  s_nop 0
  buffer_load_dwordx4 v1, s[8:11], s40 offen lds
  buffer_load_dwordx4 v2, s[8:11], s40 offen offset:1024 lds
  s_add_u32 s40, s40, s43
  v_cos_f32 v58, v220
  v_sin_f32 v66, v220
  v_add_f32 v220, v220, v219
  v_cos_f32 v59, v220
  v_sin_f32 v67, v220
  s_add_u32 m0, s47, 12288
  s_nop 0
  buffer_load_dwordx4 v1, s[8:11], s40 offen lds
  buffer_load_dwordx4 v2, s[8:11], s40 offen offset:1024 lds
  s_add_u32 s40, s40, s43
  v_add_f32 v218, 0x41800000, v218
  v_xor_b32 v44, 0x80000000, v40
  v_xor_b32 v45, 0x80000000, v41
  v_xor_b32 v46, 0x80000000, v42
  v_xor_b32 v47, 0x80000000, v43
  v_xor_b32 v52, 0x80000000, v48
  v_xor_b32 v53, 0x80000000, v49
  v_xor_b32 v54, 0x80000000, v50
  v_xor_b32 v55, 0x80000000, v51
  v_mul_f32 v219, 0x3b000000, v218
  v_mul_f32 v220, v219, v217
  v_cos_f32 v60, v220
  v_sin_f32 v68, v220
  v_add_f32 v220, v220, v219
  v_cos_f32 v61, v220
  v_sin_f32 v69, v220
  v_add_f32 v220, v220, v219
  s_add_u32 m0, s47, 14336
  s_nop 0
  buffer_load_dwordx4 v1, s[8:11], s40 offen lds
  buffer_load_dwordx4 v2, s[8:11], s40 offen offset:1024 lds
  s_bfe_u32 s71, s75, 196616
  s_mul_i32 s71, s71, 229376
  s_add_u32 s40, s41, s71
  v_cos_f32 v62, v220
  v_sin_f32 v70, v220
  v_add_f32 v220, v220, v219
  v_cos_f32 v63, v220
  v_sin_f32 v71, v220
  s_add_u32 m0, s47, 16384
  s_nop 0
  buffer_load_dwordx4 v1, s[8:11], s40 offen lds
  buffer_load_dwordx4 v2, s[8:11], s40 offen offset:1024 lds
  s_add_u32 s40, s40, s43
  s_waitcnt vmcnt(10)
  s_atomic_swap s32, s[16:17], s98
  v_and_b32 v218, 7, v216
  v_lshrrev_b32 v220, 3, v216
  v_cvt_f32_u32 v218, v218
  v_cvt_f32_u32 v220, v220
  v_mul_f32 v219, 0x3d800000, v218
  v_mul_f32 v220, 0x3e800000, v220
  v_fmac_f32 v220, v219, v217
  s_add_u32 m0, s47, 18432
  s_nop 0
  buffer_load_dwordx4 v1, s[8:11], s40 offen lds
  buffer_load_dwordx4 v2, s[8:11], s40 offen offset:1024 lds
  s_add_u32 s40, s40, s43
  v_fmamk_f32 v223, v219, 0x3f800000, v220
  v_cos_f32 v224, v220
  v_sin_f32 v226, v220
  v_cos_f32 v225, v223
  v_sin_f32 v227, v223
  v_cvt_pk_f16_f32 v72, v224, v225
  v_cvt_pk_f16_f32 v74, v226, v227
  v_fmamk_f32 v222, v219, 0x40000000, v220
  v_fmamk_f32 v223, v219, 0x40400000, v220
  v_cos_f32 v224, v222
  v_sin_f32 v226, v222
  v_cos_f32 v225, v223
  v_sin_f32 v227, v223
  v_cvt_pk_f16_f32 v73, v224, v225
  v_cvt_pk_f16_f32 v75, v226, v227
  v_cmp_eq_u32 vcc, 8, v216
  v_mov_b32 v78, 0
  v_mov_b32 v79, 0
  v_mov_b32 v77, 0xbc003c00
  v_cndmask_b32 v76, v78, v77, vcc
  v_cndmask_b32 v77, v78, v77, vcc
  s_add_u32 m0, s47, 20480
  s_nop 0
  buffer_load_dwordx4 v1, s[8:11], s40 offen lds
  buffer_load_dwordx4 v2, s[8:11], s40 offen offset:1024 lds
  s_add_u32 s40, s40, s43
  s_waitcnt lgkmcnt(2)
  v_mfma_f32_16x16x32_f16 v[136:139], v[24:27], v[40:43], 0
  v_mfma_f32_16x16x32_f16 v[140:143], v[24:27], v[48:51], 0
  v_mfma_f32_16x16x32_f16 v[144:147], v[24:27], v[44:47], 0
  v_mfma_f32_16x16x32_f16 v[148:151], v[24:27], v[52:55], 0
  ds_read_b32 v254, v7
  s_waitcnt lgkmcnt(1)
  v_mfma_f32_16x16x32_f16 v[152:155], v[28:31], v[40:43], 0
  v_mfma_f32_16x16x32_f16 v[156:159], v[28:31], v[48:51], 0
  v_mfma_f32_16x16x32_f16 v[160:163], v[28:31], v[44:47], 0
  v_mfma_f32_16x16x32_f16 v[164:167], v[28:31], v[52:55], 0
  v_pk_mul_f32 v[80:81], v[136:137], v[56:57]
  v_pk_mul_f32 v[84:85], v[140:141], v[56:57]
  v_pk_mul_f32 v[82:83], v[138:139], v[58:59]
  v_pk_mul_f32 v[86:87], v[142:143], v[58:59]
  v_pk_fma_f32 v[80:81], v[140:141], v[64:65], v[80:81]
  v_pk_fma_f32 v[84:85], v[136:137], v[64:65], v[84:85] neg_lo:[1,0,0] neg_hi:[1,0,0]
  v_pk_fma_f32 v[82:83], v[142:143], v[66:67], v[82:83]
  v_pk_fma_f32 v[86:87], v[138:139], v[66:67], v[86:87] neg_lo:[1,0,0] neg_hi:[1,0,0]
  v_cvt_pk_f16_f32 v176, v80, v81
  v_cvt_pk_f16_f32 v177, v82, v83
  v_cvt_pk_f16_f32 v178, v84, v85
  v_cvt_pk_f16_f32 v179, v86, v87
  v_pk_mul_f32 v[80:81], v[144:145], v[60:61]
  v_pk_mul_f32 v[84:85], v[148:149], v[60:61]
  v_pk_mul_f32 v[82:83], v[146:147], v[62:63]
  v_pk_mul_f32 v[86:87], v[150:151], v[62:63]
  v_pk_fma_f32 v[80:81], v[148:149], v[68:69], v[80:81]
  v_pk_fma_f32 v[84:85], v[144:145], v[68:69], v[84:85] neg_lo:[1,0,0] neg_hi:[1,0,0]
  v_pk_fma_f32 v[82:83], v[150:151], v[70:71], v[82:83]
  v_pk_fma_f32 v[86:87], v[146:147], v[70:71], v[86:87] neg_lo:[1,0,0] neg_hi:[1,0,0]
  v_cvt_pk_f16_f32 v180, v80, v81
  v_cvt_pk_f16_f32 v181, v82, v83
  v_cvt_pk_f16_f32 v182, v84, v85
  v_cvt_pk_f16_f32 v183, v86, v87
  s_add_u32 m0, s47, 22528
  s_nop 0
  buffer_load_dwordx4 v1, s[8:11], s40 offen lds
  buffer_load_dwordx4 v2, s[8:11], s40 offen offset:1024 lds
  s_bfe_u32 s71, s75, 196620
  s_mul_i32 s71, s71, 229376
  s_add_u32 s40, s41, s71
  v_pk_mul_f32 v[80:81], v[152:153], v[56:57]
  v_pk_mul_f32 v[84:85], v[156:157], v[56:57]
  v_pk_mul_f32 v[82:83], v[154:155], v[58:59]
  v_pk_mul_f32 v[86:87], v[158:159], v[58:59]
  v_pk_fma_f32 v[80:81], v[156:157], v[64:65], v[80:81]
  v_pk_fma_f32 v[84:85], v[152:153], v[64:65], v[84:85] neg_lo:[1,0,0] neg_hi:[1,0,0]
  v_pk_fma_f32 v[82:83], v[158:159], v[66:67], v[82:83]
  v_pk_fma_f32 v[86:87], v[154:155], v[66:67], v[86:87] neg_lo:[1,0,0] neg_hi:[1,0,0]
  v_cvt_pk_f16_f32 v184, v80, v81
  v_cvt_pk_f16_f32 v185, v82, v83
  v_cvt_pk_f16_f32 v186, v84, v85
  v_cvt_pk_f16_f32 v187, v86, v87
  v_pk_mul_f32 v[80:81], v[160:161], v[60:61]
  v_pk_mul_f32 v[84:85], v[164:165], v[60:61]
  v_pk_mul_f32 v[82:83], v[162:163], v[62:63]
  v_pk_mul_f32 v[86:87], v[166:167], v[62:63]
  v_pk_fma_f32 v[80:81], v[164:165], v[68:69], v[80:81]
  v_pk_fma_f32 v[84:85], v[160:161], v[68:69], v[84:85] neg_lo:[1,0,0] neg_hi:[1,0,0]
  v_pk_fma_f32 v[82:83], v[166:167], v[70:71], v[82:83]
  v_pk_fma_f32 v[86:87], v[162:163], v[70:71], v[86:87] neg_lo:[1,0,0] neg_hi:[1,0,0]
  v_cvt_pk_f16_f32 v188, v80, v81
  v_cvt_pk_f16_f32 v189, v82, v83
  v_cvt_pk_f16_f32 v190, v84, v85
  v_cvt_pk_f16_f32 v191, v86, v87
  v_mfma_f32_16x16x32_f16 v[208:211], v[76:79], v[176:179], 0
  v_mfma_f32_16x16x32_f16 v[192:195], v[72:75], v[176:179], 0
  v_mfma_f32_16x16x32_f16 v[196:199], v[72:75], v[180:183], 0
  v_mfma_f32_16x16x32_f16 v[212:215], v[76:79], v[184:187], 0
  v_mfma_f32_16x16x32_f16 v[200:203], v[72:75], v[184:187], 0
  v_mfma_f32_16x16x32_f16 v[204:207], v[72:75], v[188:191], 0
  s_add_u32 m0, s47, 24576
  s_nop 0
  buffer_load_dwordx4 v1, s[8:11], s40 offen lds
  buffer_load_dwordx4 v2, s[8:11], s40 offen offset:1024 lds
  s_add_u32 s40, s40, s43
  v_cndmask_b32 v192, v192, v208, s[60:61]
  s_nop 0
  v_cndmask_b32 v200, v200, v212, s[60:61]
  v_cvt_pk_f16_f32 v80, v192, v200
  ds_write_b32 v132, v80 offset:0
  v_cvt_pk_f16_f32 v81, v193, v201
  ds_write_b32 v132, v81 offset:256
  v_cvt_pk_f16_f32 v82, v194, v202
  ds_write_b32 v132, v82 offset:512
  v_cvt_pk_f16_f32 v83, v195, v203
  ds_write_b32 v132, v83 offset:768
  v_cvt_pk_f16_f32 v84, v196, v204
  ds_write_b32 v132, v84 offset:128
  v_cvt_pk_f16_f32 v85, v197, v205
  ds_write_b32 v132, v85 offset:384
  v_cvt_pk_f16_f32 v86, v198, v206
  ds_write_b32 v132, v86 offset:640
  v_cvt_pk_f16_f32 v87, v199, v207
  ds_write_b32 v132, v87 offset:896
  ds_read_b32 v254, v7
  s_waitcnt lgkmcnt(1)
  s_barrier
  ds_read2st64_b32 v[80:81], v133 offset0:0 offset1:8
  ds_read2st64_b32 v[82:83], v133 offset0:16 offset1:24
  ds_read2st64_b32 v[84:85], v133 offset0:1 offset1:9
  ds_read2st64_b32 v[86:87], v133 offset0:17 offset1:25
  s_waitcnt lgkmcnt(2)
  buffer_store_dwordx4 v[80:83], v7, s[16:19], s77 offen offset:0 sc1
  ds_read_b32 v254, v7
  s_waitcnt lgkmcnt(1)
  buffer_store_dwordx4 v[84:87], v7, s[16:19], s77 offen offset:1024 sc1
  v_lshrrev_b32 v11, 5, v0
  v_lshlrev_b32 v12, 3, v11
  s_lshl_b32 s50, s35, 7
  s_lshl_b32 s51, s3, 5
  s_add_u32 s50, s50, s51
  buffer_load_dwordx2 v[210:211], v12, s[24:27], s50 offen offset:0
  buffer_load_dwordx2 v[212:213], v12, s[24:27], s50 offen offset:16
  v_mov_b32 v5, v7
  v_add_u32 v6, 131072, v7
  s_lshl_b32 s45, s36, 18
  s_lshl_b32 s50, s3, 15
  s_add_u32 s45, s45, s50
  s_add_u32 s46, s45, 32768
  s_lshl_b32 s50, s63, 10
  s_add_u32 s44, s45, s50
  s_lshr_b32 s50, s36, 1
  s_lshl_b32 s50, s50, 8
  s_lshl_b32 s51, s3, 6
  s_add_u32 s50, s50, s51
  s_mul_i32 s50, s50, 16
  s_add_u32 s50, s50, 8388608
  v_mul_u32_u24 v10, 16, v0
  v_add_u32 v10, s50, v10
  s_mul_i32 s50, s36, 112
  s_lshl2_add_u32 s51, s35, s3
  s_add_u32 s50, s50, s51
  s_mul_i32 s50, s50, 16
  s_add_u32 s98, s50, 9175040
  s_add_u32 s100, s98, 16384
  s_mul_i32 s50, s36, 229376
  s_lshl_b32 s51, s51, 10
  s_add_u32 s50, s50, s51
  s_add_u32 s72, s50, 4194304
  s_add_u32 s73, s72, 114688
  s_mov_b32 s74, 16384
  s_mov_b32 s70, 0xbdd2d3e8
  v_mov_b32 v208, 0xc0135761
  s_add_u32 m0, s47, 26624
  s_nop 0
  buffer_load_dwordx4 v1, s[8:11], s40 offen lds
  buffer_load_dwordx4 v2, s[8:11], s40 offen offset:1024 lds
  s_add_u32 s40, s40, s43
  ds_read_b64_tr_b16 a[0:1], v3 offset:0
  ds_read_b64_tr_b16 a[2:3], v3 offset:512
  ds_read_b64_tr_b16 a[4:5], v4 offset:0
  ds_read_b64_tr_b16 a[6:7], v4 offset:512
  s_add_u32 m0, s47, 28672
  s_nop 0
  buffer_load_dwordx4 v1, s[8:11], s40 offen lds
  buffer_load_dwordx4 v2, s[8:11], s40 offen offset:1024 lds
  s_add_u32 s40, s40, s43
  ds_read_b64_tr_b16 a[8:9], v3 offset:2048
  ds_read_b64_tr_b16 a[10:11], v3 offset:2560
  ds_read_b64_tr_b16 a[12:13], v4 offset:2048
  ds_read_b64_tr_b16 a[14:15], v4 offset:2560
  s_add_u32 m0, s47, 30720
  s_nop 0
  buffer_load_dwordx4 v1, s[8:11], s40 offen lds
  buffer_load_dwordx4 v2, s[8:11], s40 offen offset:1024 lds
  s_bfe_u32 s71, s75, 196624
  s_mul_i32 s71, s71, 229376
  s_add_u32 s40, s41, s71
  ds_read_b64_tr_b16 a[16:17], v3 offset:4096
  ds_read_b64_tr_b16 a[18:19], v3 offset:4608
  ds_read_b64_tr_b16 a[20:21], v4 offset:4096
  ds_read_b64_tr_b16 a[22:23], v4 offset:4608
  s_waitcnt lgkmcnt(8)
  s_mov_b32 m0, s47
  s_nop 0
  buffer_load_dwordx4 v1, s[8:11], s40 offen lds
  buffer_load_dwordx4 v2, s[8:11], s40 offen offset:1024 lds
  s_add_u32 s40, s40, s43
  ds_read_b64_tr_b16 a[24:25], v3 offset:6144
  ds_read_b64_tr_b16 a[26:27], v3 offset:6656
  ds_read_b64_tr_b16 a[28:29], v4 offset:6144
  ds_read_b64_tr_b16 a[30:31], v4 offset:6656
  s_waitcnt lgkmcnt(8)
  s_add_u32 m0, s47, 2048
  s_nop 0
  buffer_load_dwordx4 v1, s[8:11], s40 offen lds
  buffer_load_dwordx4 v2, s[8:11], s40 offen offset:1024 lds
  s_add_u32 s40, s40, s43
  s_waitcnt vmcnt(12)
  s_atomic_swap s32, s[16:17], s99
  ds_read_b64_tr_b16 a[32:33], v3 offset:8192
  ds_read_b64_tr_b16 a[34:35], v3 offset:8704
  ds_read_b64_tr_b16 a[36:37], v4 offset:8192
  ds_read_b64_tr_b16 a[38:39], v4 offset:8704
  s_waitcnt lgkmcnt(8)
  s_add_u32 m0, s47, 4096
  s_nop 0
  buffer_load_dwordx4 v1, s[8:11], s40 offen lds
  buffer_load_dwordx4 v2, s[8:11], s40 offen offset:1024 lds
  s_add_u32 s40, s40, s43
  ds_read_b64_tr_b16 a[40:41], v3 offset:10240
  ds_read_b64_tr_b16 a[42:43], v3 offset:10752
  ds_read_b64_tr_b16 a[44:45], v4 offset:10240
  ds_read_b64_tr_b16 a[46:47], v4 offset:10752
  s_waitcnt lgkmcnt(8)
  s_add_u32 m0, s47, 6144
  s_nop 0
  buffer_load_dwordx4 v1, s[8:11], s40 offen lds
  buffer_load_dwordx4 v2, s[8:11], s40 offen offset:1024 lds
  s_bfe_u32 s71, s75, 196628
  s_mul_i32 s71, s71, 229376
  s_add_u32 s40, s41, s71
  ds_read_b64_tr_b16 a[48:49], v3 offset:12288
  ds_read_b64_tr_b16 a[50:51], v3 offset:12800
  ds_read_b64_tr_b16 a[52:53], v4 offset:12288
  ds_read_b64_tr_b16 a[54:55], v4 offset:12800
  s_waitcnt lgkmcnt(8)
  s_add_u32 m0, s47, 8192
  s_nop 0
  buffer_load_dwordx4 v1, s[8:11], s40 offen lds
  buffer_load_dwordx4 v2, s[8:11], s40 offen offset:1024 lds
  s_add_u32 s40, s40, s43
  ds_read_b64_tr_b16 a[56:57], v3 offset:14336
  ds_read_b64_tr_b16 a[58:59], v3 offset:14848
  ds_read_b64_tr_b16 a[60:61], v4 offset:14336
  ds_read_b64_tr_b16 a[62:63], v4 offset:14848
  s_waitcnt lgkmcnt(8)
  s_add_u32 m0, s47, 10240
  s_nop 0
  buffer_load_dwordx4 v1, s[8:11], s40 offen lds
  buffer_load_dwordx4 v2, s[8:11], s40 offen offset:1024 lds
  s_add_u32 s40, s40, s43
  ds_read_b64_tr_b16 a[64:65], v3 offset:16384
  ds_read_b64_tr_b16 a[66:67], v3 offset:16896
  ds_read_b64_tr_b16 a[68:69], v4 offset:16384
  ds_read_b64_tr_b16 a[70:71], v4 offset:16896
  s_waitcnt lgkmcnt(8)
  s_add_u32 m0, s47, 12288
  s_nop 0
  buffer_load_dwordx4 v1, s[8:11], s40 offen lds
  buffer_load_dwordx4 v2, s[8:11], s40 offen offset:1024 lds
  s_add_u32 s40, s40, s43
  ds_read_b64_tr_b16 a[72:73], v3 offset:18432
  ds_read_b64_tr_b16 a[74:75], v3 offset:18944
  ds_read_b64_tr_b16 a[76:77], v4 offset:18432
  ds_read_b64_tr_b16 a[78:79], v4 offset:18944
  s_waitcnt lgkmcnt(8)
  s_add_u32 m0, s47, 14336
  s_nop 0
  buffer_load_dwordx4 v1, s[8:11], s40 offen lds
  buffer_load_dwordx4 v2, s[8:11], s40 offen offset:1024 lds
  s_bfe_u32 s71, s75, 196632
  s_mul_i32 s71, s71, 229376
  s_add_u32 s40, s41, s71
  buffer_load_dword v9, v10, s[16:19], 0 offen sc1
  ds_read_b64_tr_b16 a[80:81], v3 offset:20480
  ds_read_b64_tr_b16 a[82:83], v3 offset:20992
  ds_read_b64_tr_b16 a[84:85], v4 offset:20480
  ds_read_b64_tr_b16 a[86:87], v4 offset:20992
  s_waitcnt lgkmcnt(8)
  s_add_u32 m0, s47, 16384
  s_nop 0
  buffer_load_dwordx4 v1, s[8:11], s40 offen lds
  buffer_load_dwordx4 v2, s[8:11], s40 offen offset:1024 lds
  s_add_u32 s40, s40, s43
  ds_read_b64_tr_b16 a[88:89], v3 offset:22528
  ds_read_b64_tr_b16 a[90:91], v3 offset:23040
  ds_read_b64_tr_b16 a[92:93], v4 offset:22528
  ds_read_b64_tr_b16 a[94:95], v4 offset:23040
  s_waitcnt lgkmcnt(8)
  s_add_u32 m0, s47, 18432
  s_nop 0
  buffer_load_dwordx4 v1, s[8:11], s40 offen lds
  buffer_load_dwordx4 v2, s[8:11], s40 offen offset:1024 lds
  s_add_u32 s40, s40, s43
  ds_read_b64_tr_b16 a[96:97], v3 offset:24576
  ds_read_b64_tr_b16 a[98:99], v3 offset:25088
  ds_read_b64_tr_b16 a[100:101], v4 offset:24576
  ds_read_b64_tr_b16 a[102:103], v4 offset:25088
  s_waitcnt lgkmcnt(8)
  s_add_u32 m0, s47, 20480
  s_nop 0
  buffer_load_dwordx4 v1, s[8:11], s40 offen lds
  buffer_load_dwordx4 v2, s[8:11], s40 offen offset:1024 lds
  s_add_u32 s40, s40, s43
  s_waitcnt vmcnt(27)
  ds_read_b64_tr_b16 a[104:105], v3 offset:26624
  ds_read_b64_tr_b16 a[106:107], v3 offset:27136
  ds_read_b64_tr_b16 a[108:109], v4 offset:26624
  ds_read_b64_tr_b16 a[110:111], v4 offset:27136
  s_waitcnt lgkmcnt(8)
  s_add_u32 m0, s47, 22528
  s_nop 0
  buffer_load_dwordx4 v1, s[8:11], s40 offen lds
  buffer_load_dwordx4 v2, s[8:11], s40 offen offset:1024 lds
  s_bfe_u32 s71, s75, 196636
  s_mul_i32 s71, s71, 229376
  s_add_u32 s40, s41, s71
  s_waitcnt vmcnt(27)
  ds_read_b64_tr_b16 a[112:113], v3 offset:28672
  ds_read_b64_tr_b16 a[114:115], v3 offset:29184
  ds_read_b64_tr_b16 a[116:117], v4 offset:28672
  ds_read_b64_tr_b16 a[118:119], v4 offset:29184
  s_waitcnt lgkmcnt(8)
  s_add_u32 m0, s47, 24576
  s_nop 0
  buffer_load_dwordx4 v1, s[8:11], s40 offen lds
  buffer_load_dwordx4 v2, s[8:11], s40 offen offset:1024 lds
  s_add_u32 s40, s40, s43
  s_waitcnt vmcnt(27)
  ds_read_b64_tr_b16 a[120:121], v3 offset:30720
  ds_read_b64_tr_b16 a[122:123], v3 offset:31232
  ds_read_b64_tr_b16 a[124:125], v4 offset:30720
  ds_read_b64_tr_b16 a[126:127], v4 offset:31232
  s_waitcnt lgkmcnt(8)
  s_add_u32 m0, s47, 26624
  s_nop 0
  buffer_load_dwordx4 v1, s[8:11], s40 offen lds
  buffer_load_dwordx4 v2, s[8:11], s40 offen offset:1024 lds
  s_add_u32 s40, s40, s43
  s_waitcnt vmcnt(12)
  v_cmp_ne_u32 vcc, s32, v9
  s_cbranch_vccz L3_ok
L4_retry:
  buffer_load_dword v9, v10, s[16:19], 0 offen sc1
  s_add_u32 s62, s62, 1
  s_cmp_gt_u32 s62, 200000
  s_waitcnt vmcnt(0)
  s_cbranch_scc1 L3_ok
  v_cmp_ne_u32 vcc, s32, v9
  s_cbranch_vccnz L4_retry
L3_ok:
  s_bfe_u32 s71, s75, 196608
  s_lshl_b32 s71, s71, 12
  s_add_u32 s44, s45, s71
  buffer_load_dwordx4 v[80:83], v5, s[16:19], s44 offen offset:0 sc1
  buffer_load_dwordx4 v[84:87], v5, s[16:19], s44 offen offset:1024 sc1
  buffer_load_dwordx4 v[88:91], v5, s[16:19], s44 offen offset:2048 sc1
  buffer_load_dwordx4 v[92:95], v5, s[16:19], s44 offen offset:3072 sc1
  s_bfe_u32 s71, s75, 196612
  s_lshl_b32 s71, s71, 12
  s_add_u32 s44, s45, s71
  buffer_load_dwordx4 v[96:99], v5, s[16:19], s44 offen offset:0 sc1
  buffer_load_dwordx4 v[100:103], v5, s[16:19], s44 offen offset:1024 sc1
  buffer_load_dwordx4 v[104:107], v5, s[16:19], s44 offen offset:2048 sc1
  buffer_load_dwordx4 v[108:111], v5, s[16:19], s44 offen offset:3072 sc1
  v_lshlrev_b32 v214, 16, v210
  v_and_b32 v215, s49, v210
  v_lshlrev_b32 v216, 16, v211
  v_and_b32 v217, s49, v211
  v_lshlrev_b32 v218, 16, v212
  v_and_b32 v219, s49, v212
  v_lshlrev_b32 v220, 16, v213
  v_and_b32 v221, s49, v213
  s_mul_i32 s50, s3, 6144
  v_add_u32 v200, s50, v7
  v_add_u32 v201, s47, v7
  s_xor_b32 s50, s3, 1
  s_mul_i32 s51, s50, 6144
  v_add_u32 v202, s51, v7
  s_lshl_b32 s51, s50, 11
  v_add_u32 v205, s51, v7
  s_xor_b32 s50, s3, 2
  s_mul_i32 s51, s50, 6144
  v_add_u32 v203, s51, v7
  s_lshl_b32 s51, s50, 15
  s_add_u32 s51, s51, 32768
  v_add_u32 v206, s51, v7
  s_xor_b32 s50, s3, 3
  s_mul_i32 s51, s50, 6144
  v_add_u32 v204, s51, v7
  s_lshl_b32 s51, s50, 15
  s_add_u32 s51, s51, 32768
  v_add_u32 v207, s51, v7
  s_lshl_b32 s50, s3, 11
  v_add_u32 v223, s50, v7
  s_waitcnt vmcnt(7)
  v_mfma_f32_32x32x16_bf16 v[16:31], a[0:3], v[80:83], 0
  s_bfe_u32 s71, s75, 196616
  s_lshl_b32 s71, s71, 12
  s_add_u32 s44, s45, s71
  buffer_load_dwordx4 v[112:115], v5, s[16:19], s44 offen offset:0 sc1
  v_mfma_f32_32x32x16_bf16 v[32:47], a[4:7], v[80:83], 0
  buffer_load_dwordx4 v[116:119], v5, s[16:19], s44 offen offset:1024 sc1
  ds_read_b64_tr_b16 a[128:129], v3 offset:0
  ds_read_b64_tr_b16 a[130:131], v3 offset:512
  ds_read_b64_tr_b16 a[132:133], v4 offset:0
  ds_read_b64_tr_b16 a[134:135], v4 offset:512
  s_waitcnt lgkmcnt(8)
  s_add_u32 m0, s47, 28672
  s_nop 0
  buffer_load_dwordx4 v1, s[8:11], s40 offen lds
  buffer_load_dwordx4 v2, s[8:11], s40 offen offset:1024 lds
  s_add_u32 s40, s40, s43
  s_waitcnt vmcnt(10)
  v_mfma_f32_32x32x16_bf16 v[16:31], a[8:11], v[84:87], v[16:31]
  buffer_load_dwordx4 v[120:123], v5, s[16:19], s44 offen offset:2048 sc1
  v_mfma_f32_32x32x16_bf16 v[32:47], a[12:15], v[84:87], v[32:47]
  buffer_load_dwordx4 v[124:127], v5, s[16:19], s44 offen offset:3072 sc1
  ds_read_b64_tr_b16 a[136:137], v3 offset:2048
  ds_read_b64_tr_b16 a[138:139], v3 offset:2560
  ds_read_b64_tr_b16 a[140:141], v4 offset:2048
  ds_read_b64_tr_b16 a[142:143], v4 offset:2560
  s_waitcnt lgkmcnt(8)
  s_add_u32 m0, s47, 30720
  s_nop 0
  buffer_load_dwordx4 v1, s[8:11], s40 offen lds
  buffer_load_dwordx4 v2, s[8:11], s40 offen offset:1024 lds
  s_waitcnt vmcnt(13)
  v_mfma_f32_32x32x16_bf16 v[16:31], a[16:19], v[88:91], v[16:31]
  s_bfe_u32 s71, s75, 196620
  s_lshl_b32 s71, s71, 12
  s_add_u32 s44, s45, s71
  buffer_load_dwordx4 v[128:131], v5, s[16:19], s44 offen offset:0 sc1
  v_mfma_f32_32x32x16_bf16 v[32:47], a[20:23], v[88:91], v[32:47]
  buffer_load_dwordx4 v[132:135], v5, s[16:19], s44 offen offset:1024 sc1
  ds_read_b64_tr_b16 a[144:145], v3 offset:4096
  ds_read_b64_tr_b16 a[146:147], v3 offset:4608
  ds_read_b64_tr_b16 a[148:149], v4 offset:4096
  ds_read_b64_tr_b16 a[150:151], v4 offset:4608
  s_mul_i32 s41, s3, 1835008
  s_lshl_b32 s50, s37, 7
  s_add_u32 s41, s41, s50
  s_mov_b32 s43, 65536
  s_waitcnt vmcnt(14)
  v_mfma_f32_32x32x16_bf16 v[16:31], a[24:27], v[92:95], v[16:31]
  buffer_load_dwordx4 v[136:139], v5, s[16:19], s44 offen offset:2048 sc1
  s_add_u32 s42, s41, 1835008
  s_lshl_b32 s50, s64, 16
  s_add_u32 s40, s41, s50
  s_mov_b32 s56, 4096
  v_mfma_f32_32x32x16_bf16 v[32:47], a[28:31], v[92:95], v[32:47]
  buffer_load_dwordx4 v[140:143], v5, s[16:19], s44 offen offset:3072 sc1
  ds_read_b64_tr_b16 a[152:153], v3 offset:6144
  ds_read_b64_tr_b16 a[154:155], v3 offset:6656
  ds_read_b64_tr_b16 a[156:157], v4 offset:6144
  ds_read_b64_tr_b16 a[158:159], v4 offset:6656
  v_lshrrev_b32 v11, 3, v0
  v_mul_lo_u32 v1, s56, v11
  v_lshlrev_b32 v11, 1, v11
  v_and_b32 v11, 4, v11
  s_waitcnt vmcnt(15)
  v_mfma_f32_32x32x16_bf16 v[16:31], a[32:35], v[96:99], v[16:31]
  s_bfe_u32 s71, s75, 196624
  s_lshl_b32 s71, s71, 12
  s_add_u32 s44, s45, s71
  buffer_load_dwordx4 v[80:83], v5, s[16:19], s44 offen offset:0 sc1
  v_xor_b32 v11, v11, v0
  v_and_b32 v11, 7, v11
  v_lshl_add_u32 v1, v11, 4, v1
  s_lshl_b32 s50, s56, 3
  v_mfma_f32_32x32x16_bf16 v[32:47], a[36:39], v[96:99], v[32:47]
  buffer_load_dwordx4 v[84:87], v5, s[16:19], s44 offen offset:1024 sc1
  ds_read_b64_tr_b16 a[160:161], v3 offset:8192
  ds_read_b64_tr_b16 a[162:163], v3 offset:8704
  ds_read_b64_tr_b16 a[164:165], v4 offset:8192
  ds_read_b64_tr_b16 a[166:167], v4 offset:8704
  s_sub_u32 s50, s50, 1024
  v_add_u32 v2, s50, v1
  s_waitcnt vmcnt(16)
  v_mfma_f32_32x32x16_bf16 v[16:31], a[40:43], v[100:103], v[16:31]
  buffer_load_dwordx4 v[88:91], v5, s[16:19], s44 offen offset:2048 sc1
  v_mfma_f32_32x32x16_bf16 v[32:47], a[44:47], v[100:103], v[32:47]
  buffer_load_dwordx4 v[92:95], v5, s[16:19], s44 offen offset:3072 sc1
  ds_read_b64_tr_b16 a[168:169], v3 offset:10240
  ds_read_b64_tr_b16 a[170:171], v3 offset:10752
  ds_read_b64_tr_b16 a[172:173], v4 offset:10240
  ds_read_b64_tr_b16 a[174:175], v4 offset:10752
  s_waitcnt vmcnt(17)
  v_mfma_f32_32x32x16_bf16 v[16:31], a[48:51], v[104:107], v[16:31]
  s_bfe_u32 s71, s75, 196628
  s_lshl_b32 s71, s71, 12
  s_add_u32 s44, s45, s71
  buffer_load_dwordx4 v[96:99], v5, s[16:19], s44 offen offset:0 sc1
  v_mfma_f32_32x32x16_bf16 v[32:47], a[52:55], v[104:107], v[32:47]
  ds_read_b64_tr_b16 a[176:177], v3 offset:12288
  ds_read_b64_tr_b16 a[178:179], v3 offset:12800
  ds_read_b64_tr_b16 a[180:181], v4 offset:12288
  ds_read_b64_tr_b16 a[182:183], v4 offset:12800
  s_waitcnt vmcnt(17)
  v_mfma_f32_32x32x16_bf16 v[16:31], a[56:59], v[108:111], v[16:31]
  buffer_load_dwordx4 v[100:103], v5, s[16:19], s44 offen offset:1024 sc1
  v_mfma_f32_32x32x16_bf16 v[32:47], a[60:63], v[108:111], v[32:47]
  ds_read_b64_tr_b16 a[184:185], v3 offset:14336
  ds_read_b64_tr_b16 a[186:187], v3 offset:14848
  ds_read_b64_tr_b16 a[188:189], v4 offset:14336
  ds_read_b64_tr_b16 a[190:191], v4 offset:14848
  s_waitcnt vmcnt(17)
  v_mfma_f32_32x32x16_bf16 v[16:31], a[64:67], v[112:115], v[16:31]
  buffer_load_dwordx4 v[104:107], v5, s[16:19], s44 offen offset:2048 sc1
  v_mfma_f32_32x32x16_bf16 v[32:47], a[68:71], v[112:115], v[32:47]
  ds_read_b64_tr_b16 a[192:193], v3 offset:16384
  ds_read_b64_tr_b16 a[194:195], v3 offset:16896
  ds_read_b64_tr_b16 a[196:197], v4 offset:16384
  ds_read_b64_tr_b16 a[198:199], v4 offset:16896
  s_waitcnt vmcnt(17)
  v_mfma_f32_32x32x16_bf16 v[16:31], a[72:75], v[116:119], v[16:31]
  buffer_load_dwordx4 v[108:111], v5, s[16:19], s44 offen offset:3072 sc1
  v_mfma_f32_32x32x16_bf16 v[32:47], a[76:79], v[116:119], v[32:47]
  ds_read_b64_tr_b16 a[200:201], v3 offset:18432
  ds_read_b64_tr_b16 a[202:203], v3 offset:18944
  ds_read_b64_tr_b16 a[204:205], v4 offset:18432
  ds_read_b64_tr_b16 a[206:207], v4 offset:18944
  s_waitcnt vmcnt(15)
  v_mfma_f32_32x32x16_bf16 v[16:31], a[80:83], v[120:123], v[16:31]
  s_bfe_u32 s71, s75, 196632
  s_lshl_b32 s71, s71, 12
  s_add_u32 s44, s45, s71
  buffer_load_dwordx4 v[112:115], v5, s[16:19], s44 offen offset:0 sc1
  v_mfma_f32_32x32x16_bf16 v[32:47], a[84:87], v[120:123], v[32:47]
  ds_read_b64_tr_b16 a[208:209], v3 offset:20480
  ds_read_b64_tr_b16 a[210:211], v3 offset:20992
  ds_read_b64_tr_b16 a[212:213], v4 offset:20480
  ds_read_b64_tr_b16 a[214:215], v4 offset:20992
  s_waitcnt vmcnt(15)
  v_mfma_f32_32x32x16_bf16 v[16:31], a[88:91], v[124:127], v[16:31]
  buffer_load_dwordx4 v[116:119], v5, s[16:19], s44 offen offset:1024 sc1
  v_mfma_f32_32x32x16_bf16 v[32:47], a[92:95], v[124:127], v[32:47]
  ds_read_b64_tr_b16 a[216:217], v3 offset:22528
  ds_read_b64_tr_b16 a[218:219], v3 offset:23040
  ds_read_b64_tr_b16 a[220:221], v4 offset:22528
  ds_read_b64_tr_b16 a[222:223], v4 offset:23040
  s_waitcnt vmcnt(13)
  v_mfma_f32_32x32x16_bf16 v[16:31], a[96:99], v[128:131], v[16:31]
  buffer_load_dwordx4 v[120:123], v5, s[16:19], s44 offen offset:2048 sc1
  v_mfma_f32_32x32x16_bf16 v[32:47], a[100:103], v[128:131], v[32:47]
  ds_read_b64_tr_b16 a[224:225], v3 offset:24576
  ds_read_b64_tr_b16 a[226:227], v3 offset:25088
  ds_read_b64_tr_b16 a[228:229], v4 offset:24576
  ds_read_b64_tr_b16 a[230:231], v4 offset:25088
  s_barrier
  s_waitcnt vmcnt(13)
  v_mfma_f32_32x32x16_bf16 v[16:31], a[104:107], v[132:135], v[16:31]
  buffer_load_dwordx4 v[124:127], v5, s[16:19], s44 offen offset:3072 sc1
  v_mfma_f32_32x32x16_bf16 v[32:47], a[108:111], v[132:135], v[32:47]
  ds_read_b64_tr_b16 a[232:233], v3 offset:26624
  ds_read_b64_tr_b16 a[234:235], v3 offset:27136
  ds_read_b64_tr_b16 a[236:237], v4 offset:26624
  ds_read_b64_tr_b16 a[238:239], v4 offset:27136
  s_waitcnt vmcnt(13)
  v_mfma_f32_32x32x16_bf16 v[16:31], a[112:115], v[136:139], v[16:31]
  s_bfe_u32 s71, s75, 196636
  s_lshl_b32 s71, s71, 12
  s_add_u32 s44, s45, s71
  buffer_load_dwordx4 v[128:131], v5, s[16:19], s44 offen offset:0 sc1
  v_mfma_f32_32x32x16_bf16 v[32:47], a[116:119], v[136:139], v[32:47]
  ds_read_b64_tr_b16 a[240:241], v3 offset:28672
  ds_read_b64_tr_b16 a[242:243], v3 offset:29184
  ds_read_b64_tr_b16 a[244:245], v4 offset:28672
  ds_read_b64_tr_b16 a[246:247], v4 offset:29184
  s_waitcnt vmcnt(13)
  v_mfma_f32_32x32x16_bf16 v[16:31], a[120:123], v[140:143], v[16:31]
  buffer_load_dwordx4 v[132:135], v5, s[16:19], s44 offen offset:1024 sc1
  v_mfma_f32_32x32x16_bf16 v[32:47], a[124:127], v[140:143], v[32:47]
  ds_read_b64_tr_b16 a[248:249], v3 offset:30720
  ds_read_b64_tr_b16 a[250:251], v3 offset:31232
  ds_read_b64_tr_b16 a[252:253], v4 offset:30720
  ds_read_b64_tr_b16 a[254:255], v4 offset:31232
  s_waitcnt vmcnt(13) lgkmcnt(15)
  v_mfma_f32_32x32x16_bf16 v[16:31], a[128:131], v[80:83], v[16:31]
  buffer_load_dwordx4 v[136:139], v5, s[16:19], s44 offen offset:2048 sc1
  v_mfma_f32_32x32x16_bf16 v[32:47], a[132:135], v[80:83], v[32:47]
  s_waitcnt vmcnt(13)
  v_mfma_f32_32x32x16_bf16 v[16:31], a[136:139], v[84:87], v[16:31]
  buffer_load_dwordx4 v[140:143], v5, s[16:19], s44 offen offset:3072 sc1
  v_mfma_f32_32x32x16_bf16 v[32:47], a[140:143], v[84:87], v[32:47]
  s_waitcnt vmcnt(13)
  v_mfma_f32_32x32x16_bf16 v[16:31], a[144:147], v[88:91], v[16:31]
  s_bfe_u32 s71, s75, 196608
  s_lshl_b32 s71, s71, 12
  s_add_u32 s44, s45, s71
  buffer_load_dwordx4 v[80:83], v6, s[16:19], s44 offen offset:0 sc1
  v_mfma_f32_32x32x16_bf16 v[32:47], a[148:151], v[88:91], v[32:47]
  s_waitcnt vmcnt(13)
  v_mfma_f32_32x32x16_bf16 v[16:31], a[152:155], v[92:95], v[16:31]
  buffer_load_dwordx4 v[84:87], v6, s[16:19], s44 offen offset:1024 sc1
  v_mfma_f32_32x32x16_bf16 v[32:47], a[156:159], v[92:95], v[32:47]
  s_waitcnt vmcnt(13)
  v_mfma_f32_32x32x16_bf16 v[16:31], a[160:163], v[96:99], v[16:31]
  buffer_load_dwordx4 v[88:91], v6, s[16:19], s44 offen offset:2048 sc1
  v_mfma_f32_32x32x16_bf16 v[32:47], a[164:167], v[96:99], v[32:47]
  s_waitcnt vmcnt(13)
  v_mfma_f32_32x32x16_bf16 v[16:31], a[168:171], v[100:103], v[16:31]
  buffer_load_dwordx4 v[92:95], v6, s[16:19], s44 offen offset:3072 sc1
  v_mfma_f32_32x32x16_bf16 v[32:47], a[172:175], v[100:103], v[32:47]
  s_waitcnt vmcnt(13)
  v_mfma_f32_32x32x16_bf16 v[16:31], a[176:179], v[104:107], v[16:31]
  s_bfe_u32 s71, s75, 196612
  s_lshl_b32 s71, s71, 12
  s_add_u32 s44, s45, s71
  buffer_load_dwordx4 v[96:99], v6, s[16:19], s44 offen offset:0 sc1
  v_mfma_f32_32x32x16_bf16 v[32:47], a[180:183], v[104:107], v[32:47]
  s_waitcnt vmcnt(13)
  v_mfma_f32_32x32x16_bf16 v[16:31], a[184:187], v[108:111], v[16:31]
  buffer_load_dwordx4 v[100:103], v6, s[16:19], s44 offen offset:1024 sc1
  v_mfma_f32_32x32x16_bf16 v[32:47], a[188:191], v[108:111], v[32:47]
  s_waitcnt vmcnt(13)
  v_mfma_f32_32x32x16_bf16 v[16:31], a[192:195], v[112:115], v[16:31]
  buffer_load_dwordx4 v[104:107], v6, s[16:19], s44 offen offset:2048 sc1
  v_mfma_f32_32x32x16_bf16 v[32:47], a[196:199], v[112:115], v[32:47]
  s_waitcnt vmcnt(13)
  v_mfma_f32_32x32x16_bf16 v[16:31], a[200:203], v[116:119], v[16:31]
  buffer_load_dwordx4 v[108:111], v6, s[16:19], s44 offen offset:3072 sc1
  v_mfma_f32_32x32x16_bf16 v[32:47], a[204:207], v[116:119], v[32:47]
  s_waitcnt vmcnt(13)
  v_mfma_f32_32x32x16_bf16 v[16:31], a[208:211], v[120:123], v[16:31]
  s_bfe_u32 s71, s75, 196616
  s_lshl_b32 s71, s71, 12
  s_add_u32 s44, s45, s71
  buffer_load_dwordx4 v[112:115], v6, s[16:19], s44 offen offset:0 sc1
  v_mfma_f32_32x32x16_bf16 v[32:47], a[212:215], v[120:123], v[32:47]
  s_waitcnt vmcnt(13)
  v_mfma_f32_32x32x16_bf16 v[16:31], a[216:219], v[124:127], v[16:31]
  buffer_load_dwordx4 v[116:119], v6, s[16:19], s44 offen offset:1024 sc1
  v_mfma_f32_32x32x16_bf16 v[32:47], a[220:223], v[124:127], v[32:47]
  s_waitcnt vmcnt(13) lgkmcnt(12)
  v_mfma_f32_32x32x16_bf16 v[16:31], a[224:227], v[128:131], v[16:31]
  buffer_load_dwordx4 v[120:123], v6, s[16:19], s44 offen offset:2048 sc1
  v_mfma_f32_32x32x16_bf16 v[32:47], a[228:231], v[128:131], v[32:47]
  s_waitcnt vmcnt(13) lgkmcnt(8)
  v_mfma_f32_32x32x16_bf16 v[16:31], a[232:235], v[132:135], v[16:31]
  buffer_load_dwordx4 v[124:127], v6, s[16:19], s44 offen offset:3072 sc1
  v_mfma_f32_32x32x16_bf16 v[32:47], a[236:239], v[132:135], v[32:47]
  s_waitcnt vmcnt(13) lgkmcnt(4)
  v_mfma_f32_32x32x16_bf16 v[16:31], a[240:243], v[136:139], v[16:31]
  s_bfe_u32 s71, s75, 196620
  s_lshl_b32 s71, s71, 12
  s_add_u32 s44, s45, s71
  buffer_load_dwordx4 v[128:131], v6, s[16:19], s44 offen offset:0 sc1
  v_mfma_f32_32x32x16_bf16 v[32:47], a[244:247], v[136:139], v[32:47]
  ds_read_b32 v254, v7
  s_waitcnt vmcnt(13) lgkmcnt(1)
  v_mfma_f32_32x32x16_bf16 v[16:31], a[248:251], v[140:143], v[16:31]
  buffer_load_dwordx4 v[132:135], v6, s[16:19], s44 offen offset:1024 sc1
  v_mfma_f32_32x32x16_bf16 v[32:47], a[252:255], v[140:143], v[32:47]
  s_mov_b32 s57, 512
  s_lshl_b32 s56, s68, 6
  v_bfe_u32 v11, v0, 2, 2
  v_lshlrev_b32 v3, 7, v11
  v_lshrrev_b32 v12, 5, v0
  v_mul_lo_u32 v12, s57, v12
  v_add_u32 v3, v3, v12
  v_lshlrev_b32 v11, 5, v11
  v_and_b32 v11, 64, v11
  v_lshlrev_b32 v12, 1, v0
  v_and_b32 v12, 32, v12
  v_and_b32 v13, 3, v0
  v_lshlrev_b32 v13, 3, v13
  v_or3_b32 v11, v11, v12, v13
  v_xor_b32 v11, s56, v11
  v_add3_u32 v3, v3, v11, s47
  v_xor_b32 v4, 64, v3
  s_waitcnt vmcnt(13)
  v_mfma_f32_32x32x16_bf16 v[48:63], a[0:3], v[80:83], 0
  buffer_load_dwordx4 v[136:139], v6, s[16:19], s44 offen offset:2048 sc1
  v_mfma_f32_32x32x16_bf16 v[64:79], a[4:7], v[80:83], 0
  s_waitcnt vmcnt(13)
  v_mfma_f32_32x32x16_bf16 v[48:63], a[8:11], v[84:87], v[48:63]
  buffer_load_dwordx4 v[140:143], v6, s[16:19], s44 offen offset:3072 sc1
  ds_write_b128 v200, v[40:43] offset:4096
  ds_write_b128 v200, v[44:47] offset:5120
  v_mfma_f32_32x32x16_bf16 v[64:79], a[12:15], v[84:87], v[64:79]
  ds_write_b128 v200, v[32:35] offset:2048
  ds_write_b128 v200, v[36:39] offset:3072
  s_waitcnt vmcnt(13)
  v_mfma_f32_32x32x16_bf16 v[48:63], a[16:19], v[88:91], v[48:63]
  s_bfe_u32 s71, s75, 196624
  s_lshl_b32 s71, s71, 12
  s_add_u32 s44, s45, s71
  buffer_load_dwordx4 v[80:83], v6, s[16:19], s44 offen offset:0 sc1
  ds_write_b128 v200, v[24:27] offset:0
  ds_write_b128 v200, v[28:31] offset:1024
  v_mfma_f32_32x32x16_bf16 v[64:79], a[20:23], v[88:91], v[64:79]
  s_waitcnt vmcnt(13)
  v_mfma_f32_32x32x16_bf16 v[48:63], a[24:27], v[92:95], v[48:63]
  buffer_load_dwordx4 v[84:87], v6, s[16:19], s44 offen offset:1024 sc1
  ds_read_b32 v254, v7
  s_waitcnt lgkmcnt(1)
  s_barrier
  ds_read_b128 v[160:163], v202 offset:0
  ds_read_b128 v[168:171], v203 offset:2048
  ds_read_b128 v[176:179], v204 offset:4096
  ds_read_b128 v[164:167], v202 offset:1024
  ds_read_b128 v[172:175], v203 offset:3072
  ds_read_b128 v[180:183], v204 offset:5120
  v_mfma_f32_32x32x16_bf16 v[64:79], a[28:31], v[92:95], v[64:79]
  s_waitcnt vmcnt(13)
  v_mfma_f32_32x32x16_bf16 v[48:63], a[32:35], v[96:99], v[48:63]
  buffer_load_dwordx4 v[88:91], v6, s[16:19], s44 offen offset:2048 sc1
  s_waitcnt lgkmcnt(3)
  v_add_f32 v16, v16, v160
  v_add_f32 v17, v17, v161
  v_add_f32 v168, v168, v176
  v_add_f32 v169, v169, v177
  v_mfma_f32_32x32x16_bf16 v[64:79], a[36:39], v[96:99], v[64:79]
  v_add_f32 v18, v18, v162
  v_add_f32 v19, v19, v163
  v_add_f32 v170, v170, v178
  v_add_f32 v171, v171, v179
  s_waitcnt vmcnt(13)
  v_mfma_f32_32x32x16_bf16 v[48:63], a[40:43], v[100:103], v[48:63]
  buffer_load_dwordx4 v[92:95], v6, s[16:19], s44 offen offset:3072 sc1
  v_add_f32 v16, v16, v168
  v_add_f32 v17, v17, v169
  v_add_f32 v18, v18, v170
  v_add_f32 v19, v19, v171
  v_mfma_f32_32x32x16_bf16 v[64:79], a[44:47], v[100:103], v[64:79]
  s_waitcnt lgkmcnt(0)
  v_add_f32 v20, v20, v164
  v_add_f32 v21, v21, v165
  v_add_f32 v172, v172, v180
  v_add_f32 v173, v173, v181
  s_waitcnt vmcnt(13)
  v_mfma_f32_32x32x16_bf16 v[48:63], a[48:51], v[104:107], v[48:63]
  s_bfe_u32 s71, s75, 196628
  s_lshl_b32 s71, s71, 12
  s_add_u32 s44, s45, s71
  buffer_load_dwordx4 v[96:99], v6, s[16:19], s44 offen offset:0 sc1
  v_add_f32 v22, v22, v166
  v_add_f32 v23, v23, v167
  v_add_f32 v174, v174, v182
  v_add_f32 v175, v175, v183
  v_mfma_f32_32x32x16_bf16 v[64:79], a[52:55], v[104:107], v[64:79]
  v_add_f32 v20, v20, v172
  v_add_f32 v21, v21, v173
  v_add_f32 v22, v22, v174
  v_add_f32 v23, v23, v175
  s_waitcnt vmcnt(13)
  v_mfma_f32_32x32x16_bf16 v[48:63], a[56:59], v[108:111], v[48:63]
  buffer_load_dwordx4 v[100:103], v6, s[16:19], s44 offen offset:1024 sc1
  v_add_f32 v16, v16, v214
  v_add_f32 v17, v17, v215
  v_add_f32 v18, v18, v216
  v_add_f32 v19, v19, v217
  v_mfma_f32_32x32x16_bf16 v[64:79], a[60:63], v[108:111], v[64:79]
  v_add_f32 v20, v20, v218
  v_add_f32 v21, v21, v219
  v_add_f32 v22, v22, v220
  v_add_f32 v23, v23, v221
  s_waitcnt vmcnt(13)
  v_mfma_f32_32x32x16_bf16 v[48:63], a[64:67], v[112:115], v[48:63]
  buffer_load_dwordx4 v[104:107], v6, s[16:19], s44 offen offset:2048 sc1
  v_mul_f32 v184, v16, v16
  v_mul_f32 v185, v17, v17
  v_mul_f32 v186, v18, v18
  v_mul_f32 v187, v19, v19
  v_mfma_f32_32x32x16_bf16 v[64:79], a[68:71], v[112:115], v[64:79]
  v_mul_f32 v188, v20, v20
  v_mul_f32 v189, v21, v21
  v_mul_f32 v190, v22, v22
  v_mul_f32 v191, v23, v23
  s_waitcnt vmcnt(13)
  v_mfma_f32_32x32x16_bf16 v[48:63], a[72:75], v[116:119], v[48:63]
  buffer_load_dwordx4 v[108:111], v6, s[16:19], s44 offen offset:3072 sc1
  v_fma_f32 v184, v184, s70, v208
  v_fma_f32 v185, v185, s70, v208
  v_fma_f32 v186, v186, s70, v208
  v_fma_f32 v187, v187, s70, v208
  v_mfma_f32_32x32x16_bf16 v[64:79], a[76:79], v[116:119], v[64:79]
  v_fma_f32 v188, v188, s70, v208
  v_fma_f32 v189, v189, s70, v208
  v_fma_f32 v190, v190, s70, v208
  v_fma_f32 v191, v191, s70, v208
  s_waitcnt vmcnt(13)
  v_mfma_f32_32x32x16_bf16 v[48:63], a[80:83], v[120:123], v[48:63]
  s_bfe_u32 s71, s75, 196632
  s_lshl_b32 s71, s71, 12
  s_add_u32 s44, s45, s71
  buffer_load_dwordx4 v[112:115], v6, s[16:19], s44 offen offset:0 sc1
  v_mul_f32 v184, v184, v16
  v_mul_f32 v185, v185, v17
  v_mul_f32 v186, v186, v18
  v_mul_f32 v187, v187, v19
  v_mfma_f32_32x32x16_bf16 v[64:79], a[84:87], v[120:123], v[64:79]
  v_mul_f32 v188, v188, v20
  v_mul_f32 v189, v189, v21
  v_mul_f32 v190, v190, v22
  v_mul_f32 v191, v191, v23
  s_waitcnt vmcnt(13)
  v_mfma_f32_32x32x16_bf16 v[48:63], a[88:91], v[124:127], v[48:63]
  buffer_load_dwordx4 v[116:119], v6, s[16:19], s44 offen offset:1024 sc1
  v_exp_f32 v184, v184
  v_exp_f32 v185, v185
  v_mfma_f32_32x32x16_bf16 v[64:79], a[92:95], v[124:127], v[64:79]
  v_exp_f32 v186, v186
  v_exp_f32 v187, v187
  s_waitcnt vmcnt(13)
  v_mfma_f32_32x32x16_bf16 v[48:63], a[96:99], v[128:131], v[48:63]
  buffer_load_dwordx4 v[120:123], v6, s[16:19], s44 offen offset:2048 sc1
  v_exp_f32 v188, v188
  v_exp_f32 v189, v189
  v_mfma_f32_32x32x16_bf16 v[64:79], a[100:103], v[128:131], v[64:79]
  v_exp_f32 v190, v190
  v_exp_f32 v191, v191
  s_waitcnt vmcnt(13)
  v_mfma_f32_32x32x16_bf16 v[48:63], a[104:107], v[132:135], v[48:63]
  buffer_load_dwordx4 v[124:127], v6, s[16:19], s44 offen offset:3072 sc1
  v_add_f32 v184, 1.0, v184
  v_add_f32 v185, 1.0, v185
  v_add_f32 v186, 1.0, v186
  v_add_f32 v187, 1.0, v187
  v_mfma_f32_32x32x16_bf16 v[64:79], a[108:111], v[132:135], v[64:79]
  v_add_f32 v188, 1.0, v188
  v_add_f32 v189, 1.0, v189
  v_add_f32 v190, 1.0, v190
  v_add_f32 v191, 1.0, v191
  s_waitcnt vmcnt(13)
  v_mfma_f32_32x32x16_bf16 v[48:63], a[112:115], v[136:139], v[48:63]
  s_bfe_u32 s71, s75, 196636
  s_lshl_b32 s71, s71, 12
  s_add_u32 s44, s45, s71
  buffer_load_dwordx4 v[128:131], v6, s[16:19], s44 offen offset:0 sc1
  v_rcp_f32 v184, v184
  v_rcp_f32 v185, v185
  v_mfma_f32_32x32x16_bf16 v[64:79], a[116:119], v[136:139], v[64:79]
  v_rcp_f32 v186, v186
  v_rcp_f32 v187, v187
  s_waitcnt vmcnt(13)
  v_mfma_f32_32x32x16_bf16 v[48:63], a[120:123], v[140:143], v[48:63]
  buffer_load_dwordx4 v[132:135], v6, s[16:19], s44 offen offset:1024 sc1
  v_rcp_f32 v188, v188
  v_rcp_f32 v189, v189
  v_mfma_f32_32x32x16_bf16 v[64:79], a[124:127], v[140:143], v[64:79]
  v_rcp_f32 v190, v190
  v_rcp_f32 v191, v191
  s_waitcnt vmcnt(13)
  v_mfma_f32_32x32x16_bf16 v[48:63], a[128:131], v[80:83], v[48:63]
  buffer_load_dwordx4 v[136:139], v6, s[16:19], s44 offen offset:2048 sc1
  v_mul_f32 v184, v184, v16
  v_mul_f32 v185, v185, v17
  v_mul_f32 v186, v186, v18
  v_mul_f32 v187, v187, v19
  v_mfma_f32_32x32x16_bf16 v[64:79], a[132:135], v[80:83], v[64:79]
  v_mul_f32 v188, v188, v20
  v_mul_f32 v189, v189, v21
  v_mul_f32 v190, v190, v22
  v_mul_f32 v191, v191, v23
  s_waitcnt vmcnt(13)
  v_mfma_f32_32x32x16_bf16 v[48:63], a[136:139], v[84:87], v[48:63]
  buffer_load_dwordx4 v[140:143], v6, s[16:19], s44 offen offset:3072 sc1
  v_cvt_pk_bf16_f32 v196, v184, v185
  v_cvt_pk_bf16_f32 v197, v186, v187
  v_cvt_pk_bf16_f32 v198, v188, v189
  v_cvt_pk_bf16_f32 v199, v190, v191
  buffer_store_dwordx4 v[196:199], v7, s[16:19], s72 offen sc1
  s_mov_b32 m0, s47
  s_nop 0
  buffer_load_dwordx4 v1, s[12:15], s40 offen lds
  v_mfma_f32_32x32x16_bf16 v[64:79], a[140:143], v[84:87], v[64:79]
  s_waitcnt vmcnt(15)
  v_mfma_f32_32x32x16_bf16 v[48:63], a[144:147], v[88:91], v[48:63]
  buffer_load_dwordx4 v2, s[12:15], s40 offen offset:1024 lds
  s_add_u32 s40, s40, s43
  v_mfma_f32_32x32x16_bf16 v[64:79], a[148:151], v[88:91], v[64:79]
  s_mul_i32 s50, s38, 112
  s_mul_i32 s51, s3, 28
  s_add_u32 s50, s50, s51
  s_mul_i32 s50, s50, 16
  s_waitcnt vmcnt(15)
  v_mfma_f32_32x32x16_bf16 v[48:63], a[152:155], v[92:95], v[48:63]
  s_add_u32 s50, s50, 9175040
  v_min_u32 v10, 27, v0
  v_mul_u32_u24 v10, 16, v10
  v_add_u32 v10, s50, v10
  s_add_u32 m0, s47, 2048
  s_nop 0
  buffer_load_dwordx4 v1, s[12:15], s40 offen lds
  v_mfma_f32_32x32x16_bf16 v[64:79], a[156:159], v[92:95], v[64:79]
  s_mov_b32 s74, 16384
  s_lshl_b32 s50, s67, 8
  v_xor_b32 v5, s50, v7
  v_add_u32 v6, 114688, v5
  s_waitcnt vmcnt(15)
  v_mfma_f32_32x32x16_bf16 v[48:63], a[160:163], v[96:99], v[48:63]
  s_mul_i32 s45, s38, 229376
  s_mul_i32 s50, s3, 28672
  s_add_u32 s45, s45, s50
  s_add_u32 s45, s45, 4194304
  buffer_load_dwordx4 v2, s[12:15], s40 offen offset:1024 lds
  s_add_u32 s40, s40, s43
  s_cmp_eq_u32 s40, s42
  s_cselect_b32 s40, s41, s40
  v_mfma_f32_32x32x16_bf16 v[64:79], a[164:167], v[96:99], v[64:79]
  s_add_u32 s46, s45, 28672
  s_lshl_b32 s50, s64, 10
  s_add_u32 s44, s45, s50
  s_waitcnt vmcnt(15)
  v_mfma_f32_32x32x16_bf16 v[48:63], a[168:171], v[100:103], v[48:63]
  s_add_u32 m0, s47, 4096
  s_nop 0
  buffer_load_dwordx4 v1, s[12:15], s40 offen lds
  v_mfma_f32_32x32x16_bf16 v[64:79], a[172:175], v[100:103], v[64:79]
  s_waitcnt vmcnt(15)
  v_mfma_f32_32x32x16_bf16 v[48:63], a[176:179], v[104:107], v[48:63]
  buffer_load_dwordx4 v2, s[12:15], s40 offen offset:1024 lds
  s_add_u32 s40, s40, s43
  v_mfma_f32_32x32x16_bf16 v[64:79], a[180:183], v[104:107], v[64:79]
  s_waitcnt vmcnt(15)
  v_mfma_f32_32x32x16_bf16 v[48:63], a[184:187], v[108:111], v[48:63]
  s_add_u32 m0, s47, 6144
  s_nop 0
  buffer_load_dwordx4 v1, s[12:15], s40 offen lds
  v_mfma_f32_32x32x16_bf16 v[64:79], a[188:191], v[108:111], v[64:79]
  s_lshr_b32 s50, s12, 7
  s_sub_u32 s50, 3, s50
  s_and_b32 s50, s50, 7
  s_and_b32 s51, s37, 24
  s_waitcnt vmcnt(15)
  v_mfma_f32_32x32x16_bf16 v[48:63], a[192:195], v[112:115], v[48:63]
  s_add_u32 s50, s50, s51
  s_lshl_b32 s50, s50, 7
  s_lshl2_add_u32 s51, s34, s3
  s_mul_i32 s51, s51, 57344
  buffer_load_dwordx4 v2, s[12:15], s40 offen offset:1024 lds
  s_add_u32 s40, s40, s43
  s_cmp_eq_u32 s40, s42
  s_cselect_b32 s40, s41, s40
  v_mfma_f32_32x32x16_bf16 v[64:79], a[196:199], v[112:115], v[64:79]
  s_add_u32 s50, s50, s51
  v_min_u32 v253, 13, v0
  v_lshlrev_b32 v253, 12, v253
  buffer_load_dword v255, v253, s[12:15], s50 offen
  s_waitcnt vmcnt(16)
  v_mfma_f32_32x32x16_bf16 v[48:63], a[200:203], v[116:119], v[48:63]
  v_min_u32 v253, 31, v0
  v_lshlrev_b32 v253, 12, v253
  s_mul_i32 s50, s38, 131072
  s_add_u32 s50, s50, 786432
  v_mfma_f32_32x32x16_bf16 v[64:79], a[204:207], v[116:119], v[64:79]
  s_mul_i32 s51, s3, 1835008
  s_add_u32 s50, s50, s51
  s_lshl_b32 s51, s37, 7
  s_add_u32 s50, s50, s51
  s_waitcnt vmcnt(15)
  v_mfma_f32_32x32x16_bf16 v[48:63], a[208:211], v[120:123], v[48:63]
  buffer_load_dword v255, v253, s[12:15], s50 offen
  v_mfma_f32_32x32x16_bf16 v[64:79], a[212:215], v[120:123], v[64:79]
  s_waitcnt vmcnt(15)
  v_mfma_f32_32x32x16_bf16 v[48:63], a[216:219], v[124:127], v[48:63]
  v_mfma_f32_32x32x16_bf16 v[64:79], a[220:223], v[124:127], v[64:79]
  s_waitcnt vmcnt(10)
  s_atomic_swap s32, s[16:17], s98
  v_mfma_f32_32x32x16_bf16 v[48:63], a[224:227], v[128:131], v[48:63]
  v_mfma_f32_32x32x16_bf16 v[64:79], a[228:231], v[128:131], v[64:79]
  v_mfma_f32_32x32x16_bf16 v[48:63], a[232:235], v[132:135], v[48:63]
  v_mfma_f32_32x32x16_bf16 v[64:79], a[236:239], v[132:135], v[64:79]
  v_mfma_f32_32x32x16_bf16 v[48:63], a[240:243], v[136:139], v[48:63]
  v_mfma_f32_32x32x16_bf16 v[64:79], a[244:247], v[136:139], v[64:79]
  v_mfma_f32_32x32x16_bf16 v[48:63], a[248:251], v[140:143], v[48:63]
  v_mfma_f32_32x32x16_bf16 v[64:79], a[252:255], v[140:143], v[64:79]
  s_nop 11
  ds_write_b128 v201, v[72:75] offset:30720
  ds_write_b128 v201, v[76:79] offset:31744
  ds_write_b128 v201, v[64:67] offset:28672
  ds_write_b128 v201, v[68:71] offset:29696
  ds_write_b128 v223, v[56:59] offset:24576
  ds_write_b128 v223, v[60:63] offset:25600
  ds_read_b32 v254, v7
  s_waitcnt lgkmcnt(1)
  s_barrier
  ds_read_b128 v[160:163], v205 offset:24576
  ds_read_b128 v[168:171], v206 offset:28672
  ds_read_b128 v[176:179], v207 offset:30720
  ds_read_b128 v[164:167], v205 offset:25600
  ds_read_b128 v[172:175], v206 offset:29696
  ds_read_b128 v[180:183], v207 offset:31744
  s_add_u32 m0, s47, 8192
  s_nop 0
  buffer_load_dwordx4 v1, s[12:15], s40 offen lds
  buffer_load_dwordx4 v2, s[12:15], s40 offen offset:1024 lds
  s_add_u32 s40, s40, s43
  s_waitcnt lgkmcnt(3)
  v_pk_add_f32 v[48:49], v[48:49], v[160:161]
  v_pk_add_f32 v[168:169], v[168:169], v[176:177]
  v_pk_add_f32 v[50:51], v[50:51], v[162:163]
  v_pk_add_f32 v[170:171], v[170:171], v[178:179]
  v_pk_add_f32 v[48:49], v[48:49], v[168:169]
  v_pk_add_f32 v[50:51], v[50:51], v[170:171]
  ds_read_b32 v254, v7
  s_waitcnt lgkmcnt(1)
  v_pk_add_f32 v[52:53], v[52:53], v[164:165]
  v_pk_add_f32 v[172:173], v[172:173], v[180:181]
  s_add_u32 m0, s47, 10240
  s_nop 0
  buffer_load_dwordx4 v1, s[12:15], s40 offen lds
  buffer_load_dwordx4 v2, s[12:15], s40 offen offset:1024 lds
  s_add_u32 s40, s40, s43
  s_cmp_eq_u32 s40, s42
  s_cselect_b32 s40, s41, s40
  v_pk_add_f32 v[54:55], v[54:55], v[166:167]
  v_pk_add_f32 v[174:175], v[174:175], v[182:183]
  v_pk_add_f32 v[52:53], v[52:53], v[172:173]
  v_pk_add_f32 v[54:55], v[54:55], v[174:175]
  v_pk_add_f32 v[48:49], v[48:49], v[214:215]
  v_pk_add_f32 v[50:51], v[50:51], v[216:217]
  v_pk_add_f32 v[52:53], v[52:53], v[218:219]
  v_pk_add_f32 v[54:55], v[54:55], v[220:221]
  v_pk_mul_f32 v[184:185], v[48:49], v[48:49]
  v_pk_mul_f32 v[186:187], v[50:51], v[50:51]
  s_add_u32 m0, s47, 12288
  s_nop 0
  buffer_load_dwordx4 v1, s[12:15], s40 offen lds
  buffer_load_dwordx4 v2, s[12:15], s40 offen offset:1024 lds
  s_add_u32 s40, s40, s43
  v_pk_mul_f32 v[188:189], v[52:53], v[52:53]
  v_pk_mul_f32 v[190:191], v[54:55], v[54:55]
  v_pk_fma_f32 v[184:185], v[184:185], s[70:71], v[208:209] op_sel_hi:[1,0,0]
  v_pk_fma_f32 v[186:187], v[186:187], s[70:71], v[208:209] op_sel_hi:[1,0,0]
  v_pk_fma_f32 v[188:189], v[188:189], s[70:71], v[208:209] op_sel_hi:[1,0,0]
  v_pk_fma_f32 v[190:191], v[190:191], s[70:71], v[208:209] op_sel_hi:[1,0,0]
  v_pk_mul_f32 v[184:185], v[184:185], v[48:49]
  v_pk_mul_f32 v[186:187], v[186:187], v[50:51]
  v_pk_mul_f32 v[188:189], v[188:189], v[52:53]
  v_pk_mul_f32 v[190:191], v[190:191], v[54:55]
  s_add_u32 m0, s47, 14336
  s_nop 0
  buffer_load_dwordx4 v1, s[12:15], s40 offen lds
  buffer_load_dwordx4 v2, s[12:15], s40 offen offset:1024 lds
  s_add_u32 s40, s40, s43
  s_cmp_eq_u32 s40, s42
  s_cselect_b32 s40, s41, s40
  v_exp_f32 v184, v184
  v_exp_f32 v185, v185
  v_exp_f32 v186, v186
  v_exp_f32 v187, v187
  v_exp_f32 v188, v188
  s_add_u32 m0, s47, 16384
  s_nop 0
  buffer_load_dwordx4 v1, s[12:15], s40 offen lds
  buffer_load_dwordx4 v2, s[12:15], s40 offen offset:1024 lds
  s_add_u32 s40, s40, s43
  v_exp_f32 v189, v189
  v_exp_f32 v190, v190
  v_exp_f32 v191, v191
  v_pk_add_f32 v[184:185], v[184:185], 1.0 op_sel_hi:[1,0]
  v_pk_add_f32 v[186:187], v[186:187], 1.0 op_sel_hi:[1,0]
  v_pk_add_f32 v[188:189], v[188:189], 1.0 op_sel_hi:[1,0]
  v_pk_add_f32 v[190:191], v[190:191], 1.0 op_sel_hi:[1,0]
  s_add_u32 m0, s47, 18432
  s_nop 0
  buffer_load_dwordx4 v1, s[12:15], s40 offen lds
  buffer_load_dwordx4 v2, s[12:15], s40 offen offset:1024 lds
  s_add_u32 s40, s40, s43
  s_cmp_eq_u32 s40, s42
  s_cselect_b32 s40, s41, s40
  v_rcp_f32 v184, v184
  v_rcp_f32 v185, v185
  v_rcp_f32 v186, v186
  v_rcp_f32 v187, v187
  v_rcp_f32 v188, v188
  v_rcp_f32 v189, v189
  buffer_load_dword v9, v10, s[16:19], 0 offen sc1
  v_rcp_f32 v190, v190
  v_rcp_f32 v191, v191
  v_pk_mul_f32 v[184:185], v[184:185], v[48:49]
  v_pk_mul_f32 v[186:187], v[186:187], v[50:51]
  v_pk_mul_f32 v[188:189], v[188:189], v[52:53]
  v_pk_mul_f32 v[190:191], v[190:191], v[54:55]
  v_cvt_pk_bf16_f32 v196, v184, v185
  v_cvt_pk_bf16_f32 v197, v186, v187
  v_cvt_pk_bf16_f32 v198, v188, v189
  v_cvt_pk_bf16_f32 v199, v190, v191
  buffer_store_dwordx4 v[196:199], v7, s[16:19], s73 offen sc1
L_join:
  s_add_u32 m0, s47, 20480
  s_nop 0
  buffer_load_dwordx4 v1, s[12:15], s40 offen lds
  buffer_load_dwordx4 v2, s[12:15], s40 offen offset:1024 lds
  s_add_u32 s40, s40, s43
  s_add_u32 m0, s47, 22528
  s_nop 0
  buffer_load_dwordx4 v1, s[12:15], s40 offen lds
  buffer_load_dwordx4 v2, s[12:15], s40 offen offset:1024 lds
  s_add_u32 s40, s40, s43
  s_cmp_eq_u32 s40, s42
  s_cselect_b32 s40, s41, s40
  s_add_u32 m0, s47, 24576
  s_nop 0
  buffer_load_dwordx4 v1, s[12:15], s40 offen lds
  buffer_load_dwordx4 v2, s[12:15], s40 offen offset:1024 lds
  s_add_u32 s40, s40, s43
  s_add_u32 m0, s47, 26624
  s_nop 0
  buffer_load_dwordx4 v1, s[12:15], s40 offen lds
  buffer_load_dwordx4 v2, s[12:15], s40 offen offset:1024 lds
  s_add_u32 s40, s40, s43
  s_cmp_eq_u32 s40, s42
  s_cselect_b32 s40, s41, s40
  s_waitcnt vmcnt(9)
  v_cmp_ne_u32 vcc, s32, v9
  s_cbranch_vccz L5_ok
  s_waitcnt vmcnt(0)
  s_atomic_swap s32, s[16:17], s100
L6_retry:
  buffer_load_dword v9, v10, s[16:19], 0 offen sc1
  s_add_u32 s62, s62, 1
  s_cmp_gt_u32 s62, 200000
  s_waitcnt vmcnt(0)
  s_cbranch_scc1 L5_ok
  v_cmp_ne_u32 vcc, s32, v9
  s_cbranch_vccnz L6_retry
L5_ok:
  buffer_load_dwordx4 v[80:83], v5, s[16:19], s44 offen offset:0 sc1
  buffer_load_dwordx4 v[84:87], v5, s[16:19], s44 offen offset:1024 sc1
  s_add_u32 s44, s44, s69
  s_cmp_eq_u32 s44, s46
  s_cselect_b32 s44, s45, s44
  buffer_load_dwordx4 v[88:91], v5, s[16:19], s44 offen offset:0 sc1
  buffer_load_dwordx4 v[92:95], v5, s[16:19], s44 offen offset:1024 sc1
  s_add_u32 s44, s44, s69
  s_cmp_eq_u32 s44, s46
  s_cselect_b32 s44, s45, s44
  buffer_load_dwordx4 v[96:99], v5, s[16:19], s44 offen offset:0 sc1
  buffer_load_dwordx4 v[100:103], v5, s[16:19], s44 offen offset:1024 sc1
  s_add_u32 s44, s44, s69
  s_cmp_eq_u32 s44, s46
  s_cselect_b32 s44, s45, s44
  ds_read_b64_tr_b16 a[0:1], v3 offset:0
  ds_read_b64_tr_b16 a[2:3], v3 offset:1024
  ds_read_b64_tr_b16 a[4:5], v4 offset:0
  ds_read_b64_tr_b16 a[6:7], v4 offset:1024
  ds_read_b64_tr_b16 a[8:9], v3 offset:2048
  ds_read_b64_tr_b16 a[10:11], v3 offset:3072
  ds_read_b64_tr_b16 a[12:13], v4 offset:2048
  ds_read_b64_tr_b16 a[14:15], v4 offset:3072
  ds_read_b64_tr_b16 a[16:17], v3 offset:4096
  ds_read_b64_tr_b16 a[18:19], v3 offset:5120
  ds_read_b64_tr_b16 a[20:21], v4 offset:4096
  ds_read_b64_tr_b16 a[22:23], v4 offset:5120
  ds_read_b64_tr_b16 a[24:25], v3 offset:6144
  ds_read_b64_tr_b16 a[26:27], v3 offset:7168
  ds_read_b64_tr_b16 a[28:29], v4 offset:6144
  ds_read_b64_tr_b16 a[30:31], v4 offset:7168
  ds_read_b64_tr_b16 a[32:33], v3 offset:8192
  ds_read_b64_tr_b16 a[34:35], v3 offset:9216
  ds_read_b64_tr_b16 a[36:37], v4 offset:8192
  ds_read_b64_tr_b16 a[38:39], v4 offset:9216
  s_waitcnt vmcnt(5) lgkmcnt(15)
  v_mfma_f32_32x32x16_bf16 v[16:31], v[80:83], a[0:3], 0
  buffer_load_dwordx4 v[104:107], v5, s[16:19], s44 offen offset:0 sc1
  v_and_b32 v11, 31, v0
  v_lshrrev_b32 v12, 5, v0
  s_lshl_b32 s50, s37, 6
  s_lshl_b32 s51, s68, 5
  s_add_u32 s50, s50, s51
  v_mfma_f32_32x32x16_bf16 v[32:47], v[80:83], a[4:7], 0
  buffer_load_dwordx4 v[108:111], v5, s[16:19], s44 offen offset:1024 sc1
  s_add_u32 s44, s44, s69
  s_cmp_eq_u32 s44, s46
  s_cselect_b32 s44, s45, s44
  ds_read_b64_tr_b16 a[40:41], v3 offset:10240
  ds_read_b64_tr_b16 a[42:43], v3 offset:11264
  ds_read_b64_tr_b16 a[44:45], v4 offset:10240
  ds_read_b64_tr_b16 a[46:47], v4 offset:11264
  s_mov_b32 m0, s47
  s_nop 0
  buffer_load_dwordx4 v1, s[12:15], s40 offen lds
  buffer_load_dwordx4 v2, s[12:15], s40 offen offset:1024 lds
  s_add_u32 s40, s40, s43
  v_add_u32 v11, s50, v11
  s_lshl_b32 s50, s38, 3
  s_lshl1_add_u32 s50, s67, s50
  v_add_u32 v12, s50, v12
  s_waitcnt vmcnt(8) lgkmcnt(15)
  v_mfma_f32_32x32x16_bf16 v[16:31], v[84:87], a[8:11], v[16:31]
  s_atomic_swap s32, s[16:17], s100
  buffer_load_dwordx4 v[112:115], v5, s[16:19], s44 offen offset:0 sc1
  v_lshlrev_b32 v224, 10, v11
  v_lshl_add_u32 v224, v12, 4, v224
  v_lshlrev_b32 v226, 1, v11
  v_mfma_f32_32x32x16_bf16 v[32:47], v[84:87], a[12:15], v[32:47]
  buffer_load_dwordx4 v[116:119], v5, s[16:19], s44 offen offset:1024 sc1
  s_add_u32 s44, s44, s69
  s_cmp_eq_u32 s44, s46
  s_cselect_b32 s44, s45, s44
  ds_read_b64_tr_b16 a[48:49], v3 offset:12288
  ds_read_b64_tr_b16 a[50:51], v3 offset:13312
  ds_read_b64_tr_b16 a[52:53], v4 offset:12288
  ds_read_b64_tr_b16 a[54:55], v4 offset:13312
  s_add_u32 m0, s47, 2048
  s_nop 0
  buffer_load_dwordx4 v1, s[12:15], s40 offen lds
  buffer_load_dwordx4 v2, s[12:15], s40 offen offset:1024 lds
  s_add_u32 s40, s40, s43
  s_cmp_eq_u32 s40, s42
  s_cselect_b32 s40, s41, s40
  v_sub_u32 v13, 0, v11
  v_and_b32 v13, 0x7ff, v13
  v_sub_u32 v14, 63, v12
  s_waitcnt vmcnt(11) lgkmcnt(15)
  v_mfma_f32_32x32x16_bf16 v[16:31], v[88:91], a[16:19], v[16:31]
  buffer_load_dwordx4 v[120:123], v5, s[16:19], s44 offen offset:0 sc1
  s_cmp_ge_u32 s38, 4
  s_cselect_b32 s79, 1, 0
  s_cselect_b64 vcc, -1, 0
  s_cselect_b32 s73, 6160384, 0
  s_cselect_b32 s73, s73, 6422528
  v_cndmask_b32 v11, v11, v13, vcc
  v_cndmask_b32 v12, v12, v14, vcc
  v_mfma_f32_32x32x16_bf16 v[32:47], v[88:91], a[20:23], v[32:47]
  buffer_load_dwordx4 v[124:127], v5, s[16:19], s44 offen offset:1024 sc1
  s_add_u32 s44, s44, s69
  s_cmp_eq_u32 s44, s46
  s_cselect_b32 s44, s45, s44
  ds_read_b64_tr_b16 a[56:57], v3 offset:14336
  ds_read_b64_tr_b16 a[58:59], v3 offset:15360
  ds_read_b64_tr_b16 a[60:61], v4 offset:14336
  ds_read_b64_tr_b16 a[62:63], v4 offset:15360
  s_add_u32 m0, s47, 4096
  s_nop 0
  buffer_load_dwordx4 v1, s[12:15], s40 offen lds
  buffer_load_dwordx4 v2, s[12:15], s40 offen offset:1024 lds
  s_add_u32 s40, s40, s43
  v_lshlrev_b32 v225, 4, v11
  v_lshl_add_u32 v225, v12, 15, v225
  s_mov_b32 s72, 6291456
  s_waitcnt vmcnt(14) lgkmcnt(15)
  v_mfma_f32_32x32x16_bf16 v[16:31], v[92:95], a[24:27], v[16:31]
  buffer_load_dwordx4 v[80:83], v5, s[16:19], s44 offen offset:0 sc1
  v_cmp_eq_u32 vcc, 31, v12
  v_and_b32 v12, 31, v11
  v_lshlrev_b32 v12, 4, v12
  v_bfe_u32 v13, v11, 5, 1
  v_lshl_add_u32 v12, v13, 11, v12
  v_bfe_u32 v13, v11, 6, 2
  v_lshl_add_u32 v12, v13, 1, v12
  s_mov_b64 s[52:53], vcc
  v_mfma_f32_32x32x16_bf16 v[32:47], v[92:95], a[28:31], v[32:47]
  buffer_load_dwordx4 v[84:87], v5, s[16:19], s44 offen offset:1024 sc1
  s_add_u32 s44, s44, s69
  s_cmp_eq_u32 s44, s46
  s_cselect_b32 s44, s45, s44
  ds_read_b64_tr_b16 a[64:65], v3 offset:16384
  ds_read_b64_tr_b16 a[66:67], v3 offset:17408
  ds_read_b64_tr_b16 a[68:69], v4 offset:16384
  ds_read_b64_tr_b16 a[70:71], v4 offset:17408
  s_add_u32 m0, s47, 6144
  s_nop 0
  buffer_load_dwordx4 v1, s[12:15], s40 offen lds
  buffer_load_dwordx4 v2, s[12:15], s40 offen offset:1024 lds
  s_add_u32 s40, s40, s43
  s_cmp_eq_u32 s40, s42
  s_cselect_b32 s40, s41, s40
  v_bfe_u32 v13, v11, 8, 1
  v_lshl_add_u32 v12, v13, 9, v12
  v_bfe_u32 v13, v11, 9, 1
  v_lshl_add_u32 v12, v13, 3, v12
  v_bfe_u32 v13, v11, 10, 1
  v_lshl_add_u32 v12, v13, 10, v12
  v_add_u32 v12, 1015808, v12
  v_cndmask_b32 v237, v225, v12, s[52:53]
  s_waitcnt vmcnt(17) lgkmcnt(15)
  v_mfma_f32_32x32x16_bf16 v[16:31], v[96:99], a[32:35], v[16:31]
  buffer_load_dwordx4 v[88:91], v5, s[16:19], s44 offen offset:0 sc1
  s_lshl_b32 s50, s38, 3
  s_sub_u32 s51, 56, s50
  s_cmp_eq_u32 s79, 0
  s_cselect_b32 s50, s50, s51
  s_lshl_b32 s50, s50, 2
  v_mfma_f32_32x32x16_bf16 v[32:47], v[96:99], a[36:39], v[32:47]
  ds_read_b64_tr_b16 a[72:73], v3 offset:18432
  ds_read_b64_tr_b16 a[74:75], v3 offset:19456
  ds_read_b64_tr_b16 a[76:77], v4 offset:18432
  ds_read_b64_tr_b16 a[78:79], v4 offset:19456
  s_add_u32 m0, s47, 8192
  s_nop 0
  buffer_load_dwordx4 v1, s[12:15], s40 offen lds
  buffer_load_dwordx4 v2, s[12:15], s40 offen offset:1024 lds
  s_add_u32 s40, s40, s43
  v_min_u32 v227, 35, v0
  v_add_u32 v227, s50, v227
  v_and_b32 v227, 127, v227
  s_waitcnt vmcnt(19) lgkmcnt(15)
  v_mfma_f32_32x32x16_bf16 v[16:31], v[100:103], a[40:43], v[16:31]
  buffer_load_dwordx4 v[92:95], v5, s[16:19], s44 offen offset:1024 sc1
  s_add_u32 s44, s44, s69
  s_cmp_eq_u32 s44, s46
  s_cselect_b32 s44, s45, s44
  v_mul_u32_u24 v227, 16, v227
  v_add_u32 v227, 10223616, v227
  s_mov_b32 s70, 0xbfb8aa3b
  v_mfma_f32_32x32x16_bf16 v[32:47], v[100:103], a[44:47], v[32:47]
  ds_read_b64_tr_b16 a[80:81], v3 offset:20480
  ds_read_b64_tr_b16 a[82:83], v3 offset:21504
  ds_read_b64_tr_b16 a[84:85], v4 offset:20480
  ds_read_b64_tr_b16 a[86:87], v4 offset:21504
  s_add_u32 m0, s47, 10240
  s_nop 0
  buffer_load_dwordx4 v1, s[12:15], s40 offen lds
  buffer_load_dwordx4 v2, s[12:15], s40 offen offset:1024 lds
  s_add_u32 s40, s40, s43
  s_cmp_eq_u32 s40, s42
  s_cselect_b32 s40, s41, s40
  s_waitcnt vmcnt(21) lgkmcnt(15)
  v_mfma_f32_32x32x16_bf16 v[16:31], v[104:107], a[48:51], v[16:31]
  buffer_load_dwordx4 v[96:99], v5, s[16:19], s44 offen offset:0 sc1
  v_mfma_f32_32x32x16_bf16 v[32:47], v[104:107], a[52:55], v[32:47]
  ds_read_b64_tr_b16 a[88:89], v3 offset:22528
  ds_read_b64_tr_b16 a[90:91], v3 offset:23552
  ds_read_b64_tr_b16 a[92:93], v4 offset:22528
  ds_read_b64_tr_b16 a[94:95], v4 offset:23552
  s_add_u32 m0, s47, 12288
  s_nop 0
  buffer_load_dwordx4 v1, s[12:15], s40 offen lds
  buffer_load_dwordx4 v2, s[12:15], s40 offen offset:1024 lds
  s_add_u32 s40, s40, s43
  s_waitcnt vmcnt(23) lgkmcnt(15)
  v_mfma_f32_32x32x16_bf16 v[16:31], v[108:111], a[56:59], v[16:31]
  buffer_load_dwordx4 v[100:103], v5, s[16:19], s44 offen offset:1024 sc1
  s_add_u32 s44, s44, s69
  s_cmp_eq_u32 s44, s46
  s_cselect_b32 s44, s45, s44
  v_mfma_f32_32x32x16_bf16 v[32:47], v[108:111], a[60:63], v[32:47]
  ds_read_b64_tr_b16 a[96:97], v3 offset:24576
  ds_read_b64_tr_b16 a[98:99], v3 offset:25600
  ds_read_b64_tr_b16 a[100:101], v4 offset:24576
  ds_read_b64_tr_b16 a[102:103], v4 offset:25600
  s_add_u32 m0, s47, 14336
  s_nop 0
  buffer_load_dwordx4 v1, s[12:15], s40 offen lds
  buffer_load_dwordx4 v2, s[12:15], s40 offen offset:1024 lds
  s_add_u32 s40, s40, s43
  s_cmp_eq_u32 s40, s42
  s_cselect_b32 s40, s41, s40
  s_waitcnt vmcnt(23) lgkmcnt(15)
  v_mfma_f32_32x32x16_bf16 v[16:31], v[112:115], a[64:67], v[16:31]
  buffer_load_dwordx4 v[104:107], v5, s[16:19], s44 offen offset:0 sc1
  v_mfma_f32_32x32x16_bf16 v[32:47], v[112:115], a[68:71], v[32:47]
  ds_read_b64_tr_b16 a[104:105], v3 offset:26624
  ds_read_b64_tr_b16 a[106:107], v3 offset:27648
  ds_read_b64_tr_b16 a[108:109], v4 offset:26624
  ds_read_b64_tr_b16 a[110:111], v4 offset:27648
  s_add_u32 m0, s47, 16384
  s_nop 0
  buffer_load_dwordx4 v1, s[12:15], s40 offen lds
  buffer_load_dwordx4 v2, s[12:15], s40 offen offset:1024 lds
  s_add_u32 s40, s40, s43
  s_waitcnt vmcnt(25) lgkmcnt(15)
  v_mfma_f32_32x32x16_bf16 v[16:31], v[116:119], a[72:75], v[16:31]
  buffer_load_dwordx4 v[108:111], v5, s[16:19], s44 offen offset:1024 sc1
  s_add_u32 s44, s44, s69
  s_cmp_eq_u32 s44, s46
  s_cselect_b32 s44, s45, s44
  v_mfma_f32_32x32x16_bf16 v[32:47], v[116:119], a[76:79], v[32:47]
  ds_read_b64_tr_b16 a[112:113], v3 offset:0
  ds_read_b64_tr_b16 a[114:115], v3 offset:1024
  ds_read_b64_tr_b16 a[116:117], v4 offset:0
  ds_read_b64_tr_b16 a[118:119], v4 offset:1024
  s_add_u32 m0, s47, 18432
  s_nop 0
  buffer_load_dwordx4 v1, s[12:15], s40 offen lds
  buffer_load_dwordx4 v2, s[12:15], s40 offen offset:1024 lds
  s_add_u32 s40, s40, s43
  s_cmp_eq_u32 s40, s42
  s_cselect_b32 s40, s41, s40
  buffer_load_dword v9, v10, s[16:19], s74 offen sc1
  s_waitcnt vmcnt(26) lgkmcnt(15)
  v_mfma_f32_32x32x16_bf16 v[16:31], v[120:123], a[80:83], v[16:31]
  buffer_load_dwordx4 v[112:115], v5, s[16:19], s44 offen offset:0 sc1
  v_mfma_f32_32x32x16_bf16 v[32:47], v[120:123], a[84:87], v[32:47]
  ds_read_b64_tr_b16 a[120:121], v3 offset:2048
  ds_read_b64_tr_b16 a[122:123], v3 offset:3072
  ds_read_b64_tr_b16 a[124:125], v4 offset:2048
  ds_read_b64_tr_b16 a[126:127], v4 offset:3072
  s_add_u32 m0, s47, 20480
  s_nop 0
  buffer_load_dwordx4 v1, s[12:15], s40 offen lds
  buffer_load_dwordx4 v2, s[12:15], s40 offen offset:1024 lds
  s_add_u32 s40, s40, s43
  s_waitcnt vmcnt(28) lgkmcnt(15)
  v_mfma_f32_32x32x16_bf16 v[16:31], v[124:127], a[88:91], v[16:31]
  buffer_load_dwordx4 v[116:119], v5, s[16:19], s44 offen offset:1024 sc1
  s_add_u32 s44, s44, s69
  s_cmp_eq_u32 s44, s46
  s_cselect_b32 s44, s45, s44
  v_mfma_f32_32x32x16_bf16 v[32:47], v[124:127], a[92:95], v[32:47]
  s_waitcnt vmcnt(27)
  ds_read_b64_tr_b16 a[128:129], v3 offset:4096
  ds_read_b64_tr_b16 a[130:131], v3 offset:5120
  ds_read_b64_tr_b16 a[132:133], v4 offset:4096
  ds_read_b64_tr_b16 a[134:135], v4 offset:5120
  s_add_u32 m0, s47, 22528
  s_nop 0
  buffer_load_dwordx4 v1, s[12:15], s40 offen lds
  buffer_load_dwordx4 v2, s[12:15], s40 offen offset:1024 lds
  s_add_u32 s40, s40, s43
  s_cmp_eq_u32 s40, s42
  s_cselect_b32 s40, s41, s40
  s_waitcnt vmcnt(28) lgkmcnt(15)
  v_mfma_f32_32x32x16_bf16 v[16:31], v[80:83], a[96:99], v[16:31]
  buffer_load_dwordx4 v[120:123], v5, s[16:19], s44 offen offset:0 sc1
  v_mfma_f32_32x32x16_bf16 v[32:47], v[80:83], a[100:103], v[32:47]
  s_waitcnt vmcnt(26)
  ds_read_b64_tr_b16 a[136:137], v3 offset:6144
  ds_read_b64_tr_b16 a[138:139], v3 offset:7168
  ds_read_b64_tr_b16 a[140:141], v4 offset:6144
  ds_read_b64_tr_b16 a[142:143], v4 offset:7168
  s_add_u32 m0, s47, 24576
  s_nop 0
  buffer_load_dwordx4 v1, s[12:15], s40 offen lds
  buffer_load_dwordx4 v2, s[12:15], s40 offen offset:1024 lds
  s_add_u32 s40, s40, s43
  s_waitcnt lgkmcnt(15)
  v_mfma_f32_32x32x16_bf16 v[16:31], v[84:87], a[104:107], v[16:31]
  buffer_load_dwordx4 v[124:127], v5, s[16:19], s44 offen offset:1024 sc1
  s_add_u32 s44, s44, s69
  s_cmp_eq_u32 s44, s46
  s_cselect_b32 s44, s45, s44
  v_mfma_f32_32x32x16_bf16 v[32:47], v[84:87], a[108:111], v[32:47]
  s_waitcnt vmcnt(26)
  ds_read_b64_tr_b16 a[144:145], v3 offset:8192
  ds_read_b64_tr_b16 a[146:147], v3 offset:9216
  ds_read_b64_tr_b16 a[148:149], v4 offset:8192
  ds_read_b64_tr_b16 a[150:151], v4 offset:9216
  s_add_u32 m0, s47, 26624
  s_nop 0
  buffer_load_dwordx4 v1, s[12:15], s40 offen lds
  buffer_load_dwordx4 v2, s[12:15], s40 offen offset:1024 lds
  s_add_u32 s40, s40, s43
  s_cmp_eq_u32 s40, s42
  s_cselect_b32 s40, s41, s40
  s_waitcnt lgkmcnt(15)
  v_mfma_f32_32x32x16_bf16 v[16:31], v[88:91], a[112:115], v[16:31]
  buffer_load_dwordx4 v[80:83], v5, s[16:19], s44 offen offset:0 sc1
  v_mfma_f32_32x32x16_bf16 v[32:47], v[88:91], a[116:119], v[32:47]
  s_waitcnt vmcnt(26)
  ds_read_b64_tr_b16 a[152:153], v3 offset:10240
  ds_read_b64_tr_b16 a[154:155], v3 offset:11264
  ds_read_b64_tr_b16 a[156:157], v4 offset:10240
  ds_read_b64_tr_b16 a[158:159], v4 offset:11264
  s_waitcnt lgkmcnt(15)
  v_mfma_f32_32x32x16_bf16 v[16:31], v[92:95], a[120:123], v[16:31]
  buffer_load_dwordx4 v[84:87], v5, s[16:19], s44 offen offset:1024 sc1
  s_add_u32 s44, s44, s69
  s_cmp_eq_u32 s44, s46
  s_cselect_b32 s44, s45, s44
  v_mfma_f32_32x32x16_bf16 v[32:47], v[92:95], a[124:127], v[32:47]
  s_waitcnt vmcnt(24)
  ds_read_b64_tr_b16 a[160:161], v3 offset:12288
  ds_read_b64_tr_b16 a[162:163], v3 offset:13312
  ds_read_b64_tr_b16 a[164:165], v4 offset:12288
  ds_read_b64_tr_b16 a[166:167], v4 offset:13312
  s_waitcnt lgkmcnt(15)
  v_mfma_f32_32x32x16_bf16 v[16:31], v[96:99], a[128:131], v[16:31]
  buffer_load_dwordx4 v[88:91], v5, s[16:19], s44 offen offset:0 sc1
  v_mfma_f32_32x32x16_bf16 v[32:47], v[96:99], a[132:135], v[32:47]
  s_waitcnt vmcnt(22)
  ds_read_b64_tr_b16 a[168:169], v3 offset:14336
  ds_read_b64_tr_b16 a[170:171], v3 offset:15360
  ds_read_b64_tr_b16 a[172:173], v4 offset:14336
  ds_read_b64_tr_b16 a[174:175], v4 offset:15360
  s_waitcnt lgkmcnt(15)
  v_mfma_f32_32x32x16_bf16 v[16:31], v[100:103], a[136:139], v[16:31]
  buffer_load_dwordx4 v[92:95], v5, s[16:19], s44 offen offset:1024 sc1
  s_add_u32 s44, s44, s69
  s_cmp_eq_u32 s44, s46
  s_cselect_b32 s44, s45, s44
  v_mfma_f32_32x32x16_bf16 v[32:47], v[100:103], a[140:143], v[32:47]
  s_waitcnt vmcnt(20)
  ds_read_b64_tr_b16 a[176:177], v3 offset:16384
  ds_read_b64_tr_b16 a[178:179], v3 offset:17408
  ds_read_b64_tr_b16 a[180:181], v4 offset:16384
  ds_read_b64_tr_b16 a[182:183], v4 offset:17408
  s_waitcnt lgkmcnt(15)
  v_mfma_f32_32x32x16_bf16 v[16:31], v[104:107], a[144:147], v[16:31]
  s_waitcnt vmcnt(16)
  v_cmp_ne_u32 vcc, s32, v9
  s_cbranch_vccz L7_ok
L8_retry:
  buffer_load_dword v9, v10, s[16:19], s74 offen sc1
  s_add_u32 s62, s62, 1
  s_cmp_gt_u32 s62, 200000
  s_waitcnt vmcnt(0)
  s_cbranch_scc1 L7_ok
  v_cmp_ne_u32 vcc, s32, v9
  s_cbranch_vccnz L8_retry
L7_ok:
  buffer_load_dwordx4 v[96:99], v6, s[16:19], s44 offen offset:0 sc1
  v_mfma_f32_32x32x16_bf16 v[32:47], v[104:107], a[148:151], v[32:47]
  ds_read_b64_tr_b16 a[184:185], v3 offset:18432
  ds_read_b64_tr_b16 a[186:187], v3 offset:19456
  ds_read_b64_tr_b16 a[188:189], v4 offset:18432
  ds_read_b64_tr_b16 a[190:191], v4 offset:19456
  s_waitcnt lgkmcnt(15)
  v_mfma_f32_32x32x16_bf16 v[16:31], v[108:111], a[152:155], v[16:31]
  buffer_load_dwordx4 v[100:103], v6, s[16:19], s44 offen offset:1024 sc1
  s_add_u32 s44, s44, s69
  s_cmp_eq_u32 s44, s46
  s_cselect_b32 s44, s45, s44
  v_mfma_f32_32x32x16_bf16 v[32:47], v[108:111], a[156:159], v[32:47]
  s_waitcnt vmcnt(15)
  ds_read_b64_tr_b16 a[192:193], v3 offset:20480
  ds_read_b64_tr_b16 a[194:195], v3 offset:21504
  ds_read_b64_tr_b16 a[196:197], v4 offset:20480
  ds_read_b64_tr_b16 a[198:199], v4 offset:21504
  s_waitcnt lgkmcnt(15)
  v_mfma_f32_32x32x16_bf16 v[16:31], v[112:115], a[160:163], v[16:31]
  buffer_load_dwordx4 v[104:107], v6, s[16:19], s44 offen offset:0 sc1
  v_mfma_f32_32x32x16_bf16 v[32:47], v[112:115], a[164:167], v[32:47]
  s_waitcnt vmcnt(13)
  ds_read_b64_tr_b16 a[200:201], v3 offset:22528
  ds_read_b64_tr_b16 a[202:203], v3 offset:23552
  ds_read_b64_tr_b16 a[204:205], v4 offset:22528
  ds_read_b64_tr_b16 a[206:207], v4 offset:23552
  buffer_load_ushort v238, v226, s[28:31], 0 offen
  buffer_load_dword v9, v227, s[16:19], 0 offen sc1
  s_waitcnt lgkmcnt(15)
  v_mfma_f32_32x32x16_bf16 v[16:31], v[116:119], a[168:171], v[16:31]
  buffer_load_dwordx4 v[108:111], v6, s[16:19], s44 offen offset:1024 sc1
  s_add_u32 s44, s44, s69
  s_cmp_eq_u32 s44, s46
  s_cselect_b32 s44, s45, s44
  v_mfma_f32_32x32x16_bf16 v[32:47], v[116:119], a[172:175], v[32:47]
  s_waitcnt vmcnt(13)
  ds_read_b64_tr_b16 a[208:209], v3 offset:24576
  ds_read_b64_tr_b16 a[210:211], v3 offset:25600
  ds_read_b64_tr_b16 a[212:213], v4 offset:24576
  ds_read_b64_tr_b16 a[214:215], v4 offset:25600
  s_waitcnt lgkmcnt(15)
  v_mfma_f32_32x32x16_bf16 v[16:31], v[120:123], a[176:179], v[16:31]
  buffer_load_dwordx4 v[112:115], v6, s[16:19], s44 offen offset:0 sc1
  v_mfma_f32_32x32x16_bf16 v[32:47], v[120:123], a[180:183], v[32:47]
  s_waitcnt vmcnt(11)
  ds_read_b64_tr_b16 a[216:217], v3 offset:26624
  ds_read_b64_tr_b16 a[218:219], v3 offset:27648
  ds_read_b64_tr_b16 a[220:221], v4 offset:26624
  ds_read_b64_tr_b16 a[222:223], v4 offset:27648
  s_waitcnt lgkmcnt(15)
  v_mfma_f32_32x32x16_bf16 v[16:31], v[124:127], a[184:187], v[16:31]
  buffer_load_dwordx4 v[116:119], v6, s[16:19], s44 offen offset:1024 sc1
  s_add_u32 s44, s44, s69
  s_cmp_eq_u32 s44, s46
  s_cselect_b32 s44, s45, s44
  v_mfma_f32_32x32x16_bf16 v[32:47], v[124:127], a[188:191], v[32:47]
  s_waitcnt vmcnt(11) lgkmcnt(12)
  v_mfma_f32_32x32x16_bf16 v[16:31], v[80:83], a[192:195], v[16:31]
  buffer_load_dwordx4 v[120:123], v6, s[16:19], s44 offen offset:0 sc1
  v_mfma_f32_32x32x16_bf16 v[32:47], v[80:83], a[196:199], v[32:47]
  s_waitcnt vmcnt(11) lgkmcnt(8)
  v_mfma_f32_32x32x16_bf16 v[16:31], v[84:87], a[200:203], v[16:31]
  buffer_load_dwordx4 v[124:127], v6, s[16:19], s44 offen offset:1024 sc1
  s_add_u32 s44, s44, s69
  s_cmp_eq_u32 s44, s46
  s_cselect_b32 s44, s45, s44
  v_mfma_f32_32x32x16_bf16 v[32:47], v[84:87], a[204:207], v[32:47]
  s_waitcnt vmcnt(11) lgkmcnt(4)
  v_mfma_f32_32x32x16_bf16 v[16:31], v[88:91], a[208:211], v[16:31]
  buffer_load_dwordx4 v[80:83], v6, s[16:19], s44 offen offset:0 sc1
  v_mfma_f32_32x32x16_bf16 v[32:47], v[88:91], a[212:215], v[32:47]
  ds_read_b32 v254, v7
  s_waitcnt vmcnt(11) lgkmcnt(1)
  v_mfma_f32_32x32x16_bf16 v[16:31], v[92:95], a[216:219], v[16:31]
  buffer_load_dwordx4 v[84:87], v6, s[16:19], s44 offen offset:1024 sc1
  s_add_u32 s44, s44, s69
  s_cmp_eq_u32 s44, s46
  s_cselect_b32 s44, s45, s44
  v_mfma_f32_32x32x16_bf16 v[32:47], v[92:95], a[220:223], v[32:47]
  s_waitcnt vmcnt(11)
  v_mfma_f32_32x32x16_bf16 v[48:63], v[96:99], a[0:3], 0
  buffer_load_dwordx4 v[88:91], v6, s[16:19], s44 offen offset:0 sc1
  v_mfma_f32_32x32x16_bf16 v[64:79], v[96:99], a[4:7], 0
  s_waitcnt vmcnt(11)
  v_mfma_f32_32x32x16_bf16 v[48:63], v[100:103], a[8:11], v[48:63]
  buffer_load_dwordx4 v[92:95], v6, s[16:19], s44 offen offset:1024 sc1
  s_add_u32 s44, s44, s69
  s_cmp_eq_u32 s44, s46
  s_cselect_b32 s44, s45, s44
  s_nop 1
  ds_write_b128 v200, v[40:43] offset:4096
  ds_write_b128 v200, v[44:47] offset:5120
  v_mfma_f32_32x32x16_bf16 v[64:79], v[100:103], a[12:15], v[64:79]
  ds_write_b128 v200, v[32:35] offset:0
  ds_write_b128 v200, v[36:39] offset:1024
  s_waitcnt vmcnt(11)
  v_mfma_f32_32x32x16_bf16 v[48:63], v[104:107], a[16:19], v[48:63]
  buffer_load_dwordx4 v[96:99], v6, s[16:19], s44 offen offset:0 sc1
  ds_write_b128 v200, v[24:27] offset:2048
  ds_write_b128 v200, v[28:31] offset:3072
  v_mfma_f32_32x32x16_bf16 v[64:79], v[104:107], a[20:23], v[64:79]
  s_waitcnt vmcnt(10)
  v_cmp_ne_u32 vcc, s32, v9
  s_cbranch_vccz L9_ok
L10_retry:
  buffer_load_dword v9, v227, s[16:19], 0 offen sc1
  s_add_u32 s62, s62, 1
  s_cmp_gt_u32 s62, 200000
  s_waitcnt vmcnt(0)
  s_cbranch_scc1 L9_ok
  v_cmp_ne_u32 vcc, s32, v9
  s_cbranch_vccnz L10_retry
L9_ok:
  buffer_load_dwordx4 v[228:231], v224, s[4:7], 0 offen offset:0
  buffer_load_dwordx4 v[232:235], v225, s[16:19], s72 offen sc1
  s_add_u32 s50, s72, 32768
  s_cmp_eq_u32 s79, 0
  s_cselect_b32 s50, s101, s50
  buffer_load_ushort v236, v237, s[16:19], s50 offen sc1
  v_lshlrev_b32 v238, 16, v238
  s_waitcnt vmcnt(12)
  v_mfma_f32_32x32x16_bf16 v[48:63], v[108:111], a[24:27], v[48:63]
  buffer_load_dwordx4 v[100:103], v6, s[16:19], s44 offen offset:1024 sc1
  s_add_u32 s44, s44, s69
  s_cmp_eq_u32 s44, s46
  s_cselect_b32 s44, s45, s44
  ds_read_b32 v254, v7
  s_waitcnt lgkmcnt(1)
  s_barrier
  ds_read_b128 v[160:163], v202 offset:0
  ds_read_b128 v[168:171], v203 offset:2048
  ds_read_b128 v[176:179], v204 offset:4096
  v_mfma_f32_32x32x16_bf16 v[64:79], v[108:111], a[28:31], v[64:79]
  ds_read_b128 v[164:167], v202 offset:1024
  ds_read_b128 v[172:175], v203 offset:3072
  ds_read_b128 v[180:183], v204 offset:5120
  s_waitcnt vmcnt(12)
  v_mfma_f32_32x32x16_bf16 v[48:63], v[112:115], a[32:35], v[48:63]
  buffer_load_dwordx4 v[104:107], v6, s[16:19], s44 offen offset:0 sc1
  s_waitcnt lgkmcnt(3)
  v_add_f32 v16, v16, v160
  v_add_f32 v17, v17, v161
  v_mfma_f32_32x32x16_bf16 v[64:79], v[112:115], a[36:39], v[64:79]
  v_add_f32 v168, v168, v176
  v_add_f32 v169, v169, v177
  v_add_f32 v18, v18, v162
  v_add_f32 v19, v19, v163
  s_waitcnt vmcnt(12)
  v_mfma_f32_32x32x16_bf16 v[48:63], v[116:119], a[40:43], v[48:63]
  buffer_load_dwordx4 v[108:111], v6, s[16:19], s44 offen offset:1024 sc1
  s_add_u32 s44, s44, s69
  s_cmp_eq_u32 s44, s46
  s_cselect_b32 s44, s45, s44
  v_add_f32 v170, v170, v178
  v_add_f32 v171, v171, v179
  v_add_f32 v16, v16, v168
  v_add_f32 v17, v17, v169
  v_mfma_f32_32x32x16_bf16 v[64:79], v[116:119], a[44:47], v[64:79]
  v_add_f32 v18, v18, v170
  v_add_f32 v19, v19, v171
  ds_read_b32 v254, v7
  s_waitcnt lgkmcnt(1)
  v_add_f32 v20, v20, v164
  v_add_f32 v21, v21, v165
  s_waitcnt vmcnt(12)
  v_mfma_f32_32x32x16_bf16 v[48:63], v[120:123], a[48:51], v[48:63]
  buffer_load_dwordx4 v[112:115], v6, s[16:19], s44 offen offset:0 sc1
  v_add_f32 v172, v172, v180
  v_add_f32 v173, v173, v181
  v_add_f32 v22, v22, v166
  v_add_f32 v23, v23, v167
  v_mfma_f32_32x32x16_bf16 v[64:79], v[120:123], a[52:55], v[64:79]
  v_add_f32 v174, v174, v182
  v_add_f32 v175, v175, v183
  v_add_f32 v20, v20, v172
  v_add_f32 v21, v21, v173
  s_waitcnt vmcnt(12)
  v_mfma_f32_32x32x16_bf16 v[48:63], v[124:127], a[56:59], v[48:63]
  buffer_load_dwordx4 v[116:119], v6, s[16:19], s44 offen offset:1024 sc1
  s_add_u32 s44, s44, s69
  s_cmp_eq_u32 s44, s46
  s_cselect_b32 s44, s45, s44
  v_add_f32 v22, v22, v174
  v_add_f32 v23, v23, v175
  v_permlane32_swap_b32 v16, v20
  v_permlane32_swap_b32 v17, v21
  v_mfma_f32_32x32x16_bf16 v[64:79], v[124:127], a[60:63], v[64:79]
  v_permlane32_swap_b32 v18, v22
  v_permlane32_swap_b32 v19, v23
  v_add_f32 v16, v16, v238
  v_add_f32 v17, v17, v238
  s_waitcnt vmcnt(12)
  v_mfma_f32_32x32x16_bf16 v[48:63], v[80:83], a[64:67], v[48:63]
  buffer_load_dwordx4 v[120:123], v6, s[16:19], s44 offen offset:0 sc1
  v_add_f32 v18, v18, v238
  v_add_f32 v19, v19, v238
  v_add_f32 v20, v20, v238
  v_add_f32 v21, v21, v238
  v_mfma_f32_32x32x16_bf16 v[64:79], v[80:83], a[68:71], v[64:79]
  v_add_f32 v22, v22, v238
  v_add_f32 v23, v23, v238
  v_mul_f32 v184, s70, v16
  v_mul_f32 v185, s70, v17
  s_waitcnt vmcnt(12)
  v_mfma_f32_32x32x16_bf16 v[48:63], v[84:87], a[72:75], v[48:63]
  buffer_load_dwordx4 v[124:127], v6, s[16:19], s44 offen offset:1024 sc1
  s_add_u32 s44, s44, s69
  s_cmp_eq_u32 s44, s46
  s_cselect_b32 s44, s45, s44
  v_mul_f32 v186, s70, v18
  v_mul_f32 v187, s70, v19
  v_mul_f32 v188, s70, v20
  v_mul_f32 v189, s70, v21
  v_mfma_f32_32x32x16_bf16 v[64:79], v[84:87], a[76:79], v[64:79]
  v_mul_f32 v190, s70, v22
  v_mul_f32 v191, s70, v23
  v_exp_f32 v184, v184
  s_waitcnt vmcnt(12)
  v_mfma_f32_32x32x16_bf16 v[48:63], v[88:91], a[80:83], v[48:63]
  buffer_load_dwordx4 v[80:83], v6, s[16:19], s44 offen offset:0 sc1
  v_exp_f32 v185, v185
  v_exp_f32 v186, v186
  v_mfma_f32_32x32x16_bf16 v[64:79], v[88:91], a[84:87], v[64:79]
  v_exp_f32 v187, v187
  v_exp_f32 v188, v188
  s_waitcnt vmcnt(12)
  v_mfma_f32_32x32x16_bf16 v[48:63], v[92:95], a[88:91], v[48:63]
  buffer_load_dwordx4 v[84:87], v6, s[16:19], s44 offen offset:1024 sc1
  s_add_u32 s44, s44, s69
  s_cmp_eq_u32 s44, s46
  s_cselect_b32 s44, s45, s44
  v_exp_f32 v189, v189
  v_exp_f32 v190, v190
  v_mfma_f32_32x32x16_bf16 v[64:79], v[92:95], a[92:95], v[64:79]
  v_exp_f32 v191, v191
  v_add_f32 v184, 1.0, v184
  v_add_f32 v185, 1.0, v185
  s_waitcnt vmcnt(12)
  v_mfma_f32_32x32x16_bf16 v[48:63], v[96:99], a[96:99], v[48:63]
  buffer_load_dwordx4 v[88:91], v6, s[16:19], s44 offen offset:0 sc1
  v_add_f32 v186, 1.0, v186
  v_add_f32 v187, 1.0, v187
  v_add_f32 v188, 1.0, v188
  v_add_f32 v189, 1.0, v189
  v_mfma_f32_32x32x16_bf16 v[64:79], v[96:99], a[100:103], v[64:79]
  v_add_f32 v190, 1.0, v190
  v_add_f32 v191, 1.0, v191
  v_rcp_f32 v184, v184
  s_waitcnt vmcnt(9)
  v_mfma_f32_32x32x16_bf16 v[48:63], v[100:103], a[104:107], v[48:63]
  buffer_load_dwordx4 v[92:95], v6, s[16:19], s44 offen offset:1024 sc1
  s_add_u32 s44, s44, s69
  s_cmp_eq_u32 s44, s46
  s_cselect_b32 s44, s45, s44
  v_rcp_f32 v185, v185
  v_rcp_f32 v186, v186
  v_mfma_f32_32x32x16_bf16 v[64:79], v[100:103], a[108:111], v[64:79]
  v_rcp_f32 v187, v187
  v_rcp_f32 v188, v188
  s_waitcnt vmcnt(9)
  v_mfma_f32_32x32x16_bf16 v[48:63], v[104:107], a[112:115], v[48:63]
  buffer_load_dwordx4 v[96:99], v6, s[16:19], s44 offen offset:0 sc1
  v_rcp_f32 v189, v189
  v_rcp_f32 v190, v190
  v_mfma_f32_32x32x16_bf16 v[64:79], v[104:107], a[116:119], v[64:79]
  v_rcp_f32 v191, v191
  v_mul_f32 v184, v184, v16
  v_mul_f32 v185, v185, v17
  s_waitcnt vmcnt(9)
  v_mfma_f32_32x32x16_bf16 v[48:63], v[108:111], a[120:123], v[48:63]
  buffer_load_dwordx4 v[100:103], v6, s[16:19], s44 offen offset:1024 sc1
  s_add_u32 s44, s44, s69
  s_cmp_eq_u32 s44, s46
  s_cselect_b32 s44, s45, s44
  v_mul_f32 v186, v186, v18
  v_mul_f32 v187, v187, v19
  v_mul_f32 v188, v188, v20
  v_mul_f32 v189, v189, v21
  v_mfma_f32_32x32x16_bf16 v[64:79], v[108:111], a[124:127], v[64:79]
  v_mul_f32 v190, v190, v22
  v_mul_f32 v191, v191, v23
  v_lshlrev_b32 v240, 16, v228
  v_and_b32 v241, s49, v228
  s_waitcnt vmcnt(9)
  v_mfma_f32_32x32x16_bf16 v[48:63], v[112:115], a[128:131], v[48:63]
  buffer_load_dwordx4 v[104:107], v6, s[16:19], s44 offen offset:0 sc1
  v_lshlrev_b32 v242, 16, v229
  v_and_b32 v243, s49, v229
  v_lshlrev_b32 v244, 16, v230
  v_and_b32 v245, s49, v230
  v_mfma_f32_32x32x16_bf16 v[64:79], v[112:115], a[132:135], v[64:79]
  v_lshlrev_b32 v246, 16, v231
  v_and_b32 v247, s49, v231
  s_cmp_eq_u32 s79, 0
  s_cbranch_scc1 L11_direct
  v_bfi_b32 v236, s49, v235, v236
  v_bfi_b32 v228, s49, v234, v235
  v_bfi_b32 v235, s49, v232, v233
  v_bfi_b32 v234, s49, v233, v234
  v_mov_b32 v232, v236
  v_mov_b32 v233, v228
L11_direct:
  s_waitcnt vmcnt(9)
  v_mfma_f32_32x32x16_bf16 v[48:63], v[116:119], a[136:139], v[48:63]
  buffer_load_dwordx4 v[108:111], v6, s[16:19], s44 offen offset:1024 sc1
  s_add_u32 s44, s44, s69
  s_cmp_eq_u32 s44, s46
  s_cselect_b32 s44, s45, s44
  v_lshlrev_b32 v210, 16, v232
  v_and_b32 v211, s49, v232
  v_lshlrev_b32 v212, 16, v233
  v_and_b32 v213, s49, v233
  v_mfma_f32_32x32x16_bf16 v[64:79], v[116:119], a[140:143], v[64:79]
  v_lshlrev_b32 v214, 16, v234
  v_and_b32 v215, s49, v234
  v_lshlrev_b32 v216, 16, v235
  v_and_b32 v217, s49, v235
  s_waitcnt vmcnt(9)
  v_mfma_f32_32x32x16_bf16 v[48:63], v[120:123], a[144:147], v[48:63]
  buffer_load_dwordx4 v[228:231], v224, s[4:7], 0 offen offset:64
  buffer_load_dwordx4 v[232:235], v225, s[16:19], s73 offen sc1
  s_add_u32 s50, s73, 32768
  s_cmp_eq_u32 s79, 0
  s_cselect_b32 s50, s101, s50
  buffer_load_ushort v236, v225, s[16:19], s50 offen sc1
  v_fma_f32 v184, v184, v210, v240
  v_fma_f32 v185, v185, v211, v241
  v_fma_f32 v186, v186, v212, v242
  v_fma_f32 v187, v187, v213, v243
  v_mfma_f32_32x32x16_bf16 v[64:79], v[120:123], a[148:151], v[64:79]
  v_fma_f32 v188, v188, v214, v244
  v_fma_f32 v189, v189, v215, v245
  v_fma_f32 v190, v190, v216, v246
  v_fma_f32 v191, v191, v217, v247
  s_waitcnt vmcnt(11)
  v_mfma_f32_32x32x16_bf16 v[48:63], v[124:127], a[152:155], v[48:63]
  v_cvt_pk_bf16_f32 v196, v184, v185
  v_cvt_pk_bf16_f32 v197, v186, v187
  v_cvt_pk_bf16_f32 v198, v188, v189
  v_cvt_pk_bf16_f32 v199, v190, v191
  buffer_store_dwordx4 v[196:199], v224, s[20:23], 0 offen offset:0
  v_mfma_f32_32x32x16_bf16 v[64:79], v[124:127], a[156:159], v[64:79]
  s_waitcnt vmcnt(11)
  v_mfma_f32_32x32x16_bf16 v[48:63], v[80:83], a[160:163], v[48:63]
  v_mfma_f32_32x32x16_bf16 v[64:79], v[80:83], a[164:167], v[64:79]
  s_waitcnt vmcnt(10)
  v_mfma_f32_32x32x16_bf16 v[48:63], v[84:87], a[168:171], v[48:63]
  v_mfma_f32_32x32x16_bf16 v[64:79], v[84:87], a[172:175], v[64:79]
  s_waitcnt vmcnt(9)
  v_mfma_f32_32x32x16_bf16 v[48:63], v[88:91], a[176:179], v[48:63]
  v_mfma_f32_32x32x16_bf16 v[64:79], v[88:91], a[180:183], v[64:79]
  s_waitcnt vmcnt(8)
  v_mfma_f32_32x32x16_bf16 v[48:63], v[92:95], a[184:187], v[48:63]
  v_mfma_f32_32x32x16_bf16 v[64:79], v[92:95], a[188:191], v[64:79]
  s_waitcnt vmcnt(7)
  v_mfma_f32_32x32x16_bf16 v[48:63], v[96:99], a[192:195], v[48:63]
  v_mfma_f32_32x32x16_bf16 v[64:79], v[96:99], a[196:199], v[64:79]
  s_waitcnt vmcnt(6)
  v_mfma_f32_32x32x16_bf16 v[48:63], v[100:103], a[200:203], v[48:63]
  v_mfma_f32_32x32x16_bf16 v[64:79], v[100:103], a[204:207], v[64:79]
  s_waitcnt vmcnt(5)
  v_mfma_f32_32x32x16_bf16 v[48:63], v[104:107], a[208:211], v[48:63]
  v_mfma_f32_32x32x16_bf16 v[64:79], v[104:107], a[212:215], v[64:79]
  s_waitcnt vmcnt(4)
  v_mfma_f32_32x32x16_bf16 v[48:63], v[108:111], a[216:219], v[48:63]
  v_mfma_f32_32x32x16_bf16 v[64:79], v[108:111], a[220:223], v[64:79]
  s_nop 11
  ds_write_b128 v201, v[72:75] offset:30720
  ds_write_b128 v201, v[76:79] offset:31744
  ds_write_b128 v223, v[64:67] offset:24576
  ds_write_b128 v223, v[68:71] offset:25600
  ds_write_b128 v201, v[56:59] offset:28672
  ds_write_b128 v201, v[60:63] offset:29696
  s_waitcnt vmcnt(1)
  v_lshlrev_b32 v240, 16, v228
  v_and_b32 v241, s49, v228
  v_lshlrev_b32 v242, 16, v229
  v_and_b32 v243, s49, v229
  v_lshlrev_b32 v244, 16, v230
  v_and_b32 v245, s49, v230
  v_lshlrev_b32 v246, 16, v231
  v_and_b32 v247, s49, v231
  s_cmp_eq_u32 s79, 0
  s_cbranch_scc1 L12_direct
  v_bfi_b32 v236, s49, v235, v236
  v_bfi_b32 v228, s49, v234, v235
  v_bfi_b32 v235, s49, v232, v233
  v_bfi_b32 v234, s49, v233, v234
  v_mov_b32 v232, v236
  v_mov_b32 v233, v228
L12_direct:
  v_lshlrev_b32 v210, 16, v232
  v_and_b32 v211, s49, v232
  v_lshlrev_b32 v212, 16, v233
  v_and_b32 v213, s49, v233
  v_lshlrev_b32 v214, 16, v234
  v_and_b32 v215, s49, v234
  v_lshlrev_b32 v216, 16, v235
  v_and_b32 v217, s49, v235
  s_waitcnt lgkmcnt(0)
  s_barrier
  ds_read_b128 v[160:163], v205 offset:24576
  ds_read_b128 v[168:171], v206 offset:28672
  ds_read_b128 v[176:179], v207 offset:30720
  ds_read_b128 v[164:167], v205 offset:25600
  ds_read_b128 v[172:175], v206 offset:29696
  ds_read_b128 v[180:183], v207 offset:31744
  s_waitcnt lgkmcnt(3)
  v_pk_add_f32 v[48:49], v[48:49], v[160:161]
  v_pk_add_f32 v[168:169], v[168:169], v[176:177]
  v_pk_add_f32 v[50:51], v[50:51], v[162:163]
  v_pk_add_f32 v[170:171], v[170:171], v[178:179]
  v_pk_add_f32 v[48:49], v[48:49], v[168:169]
  v_pk_add_f32 v[50:51], v[50:51], v[170:171]
  s_waitcnt lgkmcnt(0)
  v_pk_add_f32 v[52:53], v[52:53], v[164:165]
  v_pk_add_f32 v[172:173], v[172:173], v[180:181]
  v_pk_add_f32 v[54:55], v[54:55], v[166:167]
  v_pk_add_f32 v[174:175], v[174:175], v[182:183]
  v_pk_add_f32 v[52:53], v[52:53], v[172:173]
  v_pk_add_f32 v[54:55], v[54:55], v[174:175]
  s_nop 0
  v_permlane32_swap_b32 v48, v52
  v_permlane32_swap_b32 v49, v53
  v_permlane32_swap_b32 v50, v54
  v_permlane32_swap_b32 v51, v55
  v_pk_add_f32 v[48:49], v[48:49], v[238:239] op_sel:[0,0] op_sel_hi:[1,0]
  v_pk_add_f32 v[50:51], v[50:51], v[238:239] op_sel:[0,0] op_sel_hi:[1,0]
  v_pk_add_f32 v[52:53], v[52:53], v[238:239] op_sel:[0,0] op_sel_hi:[1,0]
  v_pk_add_f32 v[54:55], v[54:55], v[238:239] op_sel:[0,0] op_sel_hi:[1,0]
  v_pk_mul_f32 v[184:185], v[48:49], s[70:71] op_sel_hi:[1,0]
  v_pk_mul_f32 v[186:187], v[50:51], s[70:71] op_sel_hi:[1,0]
  v_pk_mul_f32 v[188:189], v[52:53], s[70:71] op_sel_hi:[1,0]
  v_pk_mul_f32 v[190:191], v[54:55], s[70:71] op_sel_hi:[1,0]
  v_exp_f32 v184, v184
  v_exp_f32 v185, v185
  v_exp_f32 v186, v186
  v_exp_f32 v187, v187
  v_exp_f32 v188, v188
  v_exp_f32 v189, v189
  v_exp_f32 v190, v190
  v_exp_f32 v191, v191
  v_pk_add_f32 v[184:185], v[184:185], 1.0 op_sel_hi:[1,0]
  v_pk_add_f32 v[186:187], v[186:187], 1.0 op_sel_hi:[1,0]
  v_pk_add_f32 v[188:189], v[188:189], 1.0 op_sel_hi:[1,0]
  v_pk_add_f32 v[190:191], v[190:191], 1.0 op_sel_hi:[1,0]
  v_rcp_f32 v184, v184
  v_rcp_f32 v185, v185
  v_rcp_f32 v186, v186
  v_rcp_f32 v187, v187
  v_rcp_f32 v188, v188
  v_rcp_f32 v189, v189
  v_rcp_f32 v190, v190
  v_rcp_f32 v191, v191
  v_pk_mul_f32 v[184:185], v[184:185], v[48:49]
  v_pk_mul_f32 v[186:187], v[186:187], v[50:51]
  v_pk_mul_f32 v[188:189], v[188:189], v[52:53]
  v_pk_mul_f32 v[190:191], v[190:191], v[54:55]
  v_pk_fma_f32 v[184:185], v[184:185], v[210:211], v[240:241]
  v_pk_fma_f32 v[186:187], v[186:187], v[212:213], v[242:243]
  v_pk_fma_f32 v[188:189], v[188:189], v[214:215], v[244:245]
  v_pk_fma_f32 v[190:191], v[190:191], v[216:217], v[246:247]
  v_cvt_pk_bf16_f32 v196, v184, v185
  v_cvt_pk_bf16_f32 v197, v186, v187
  v_cvt_pk_bf16_f32 v198, v188, v189
  v_cvt_pk_bf16_f32 v199, v190, v191
  buffer_store_dwordx4 v[196:199], v224, s[20:23], 0 offen offset:64
  s_endpgm
L_fft:
  v_fmamk_f32 v222, v219, 0x40000000, v220
  v_fmamk_f32 v223, v219, 0x40400000, v220
  v_cos_f32 v224, v222
  v_sin_f32 v226, v222
  v_cos_f32 v225, v223
  v_sin_f32 v227, v223
  v_cvt_pk_f16_f32 v41, v224, v225
  v_cvt_pk_f16_f32 v49, v226, v227
  v_fmamk_f32 v222, v219, 0x41800000, v220
  v_fmamk_f32 v223, v219, 0x41880000, v220
  v_cos_f32 v224, v222
  v_sin_f32 v226, v222
  v_cos_f32 v225, v223
  v_sin_f32 v227, v223
  v_cvt_pk_f16_f32 v42, v224, v225
  v_cvt_pk_f16_f32 v50, v226, v227
  v_fmamk_f32 v222, v219, 0x41900000, v220
  v_fmamk_f32 v223, v219, 0x41980000, v220
  v_cos_f32 v224, v222
  v_sin_f32 v226, v222
  v_cos_f32 v225, v223
  v_sin_f32 v227, v223
  v_cvt_pk_f16_f32 v43, v224, v225
  v_cvt_pk_f16_f32 v51, v226, v227
  v_mul_f32 v219, 0x3b000000, v218
  v_mul_f32 v220, v219, v217
  v_cos_f32 v56, v220
  v_sin_f32 v64, v220
  v_add_f32 v220, v220, v219
  v_cos_f32 v57, v220
  v_sin_f32 v65, v220
  v_add_f32 v220, v220, v219
  v_cos_f32 v58, v220
  v_sin_f32 v66, v220
  v_add_f32 v220, v220, v219
  v_cos_f32 v59, v220
  v_sin_f32 v67, v220
  v_add_f32 v218, 0x41800000, v218
  v_xor_b32 v44, 0x80000000, v40
  v_xor_b32 v45, 0x80000000, v41
  v_xor_b32 v46, 0x80000000, v42
  v_xor_b32 v47, 0x80000000, v43
  v_xor_b32 v52, 0x80000000, v48
  v_xor_b32 v53, 0x80000000, v49
  v_xor_b32 v54, 0x80000000, v50
  v_xor_b32 v55, 0x80000000, v51
  v_mul_f32 v219, 0x3b000000, v218
  v_mul_f32 v220, v219, v217
  v_cos_f32 v60, v220
  v_sin_f32 v68, v220
  v_add_f32 v220, v220, v219
  v_cos_f32 v61, v220
  v_sin_f32 v69, v220
  v_add_f32 v220, v220, v219
  v_cos_f32 v62, v220
  v_sin_f32 v70, v220
  v_add_f32 v220, v220, v219
  v_cos_f32 v63, v220
  v_sin_f32 v71, v220
  v_and_b32 v218, 7, v216
  v_lshrrev_b32 v220, 3, v216
  v_cvt_f32_u32 v218, v218
  v_cvt_f32_u32 v220, v220
  v_mul_f32 v219, 0x3d800000, v218
  v_mul_f32 v220, 0x3e800000, v220
  v_fmac_f32 v220, v219, v217
  s_waitcnt vmcnt(0)
  s_atomic_swap s32, s[16:17], s98
  v_lshrrev_b32 v253, 3, v0
  v_lshlrev_b32 v253, 12, v253
  v_and_b32 v252, 7, v0
  v_lshl_add_u32 v253, v252, 7, v253
  s_and_b32 s50, s39, 7
  s_lshl_b32 s50, s50, 15
  s_mul_i32 s76, s3, 1835008
  s_add_u32 s76, s76, s50
  s_lshr_b32 s50, s33, 1
  s_lshl_b32 s50, s50, 10
  s_add_u32 s76, s76, s50
  s_cmp_eq_u32 s39, 0
  s_cselect_b32 s76, 7340032, s76
  buffer_load_dword v255, v253, s[12:15], s76 offen
  s_add_u32 s76, s76, 262144
  v_fmamk_f32 v223, v219, 0x3f800000, v220
  v_cos_f32 v224, v220
  v_sin_f32 v226, v220
  v_cos_f32 v225, v223
  v_sin_f32 v227, v223
  v_cvt_pk_f16_f32 v72, v224, v225
  v_cvt_pk_f16_f32 v74, v226, v227
  v_fmamk_f32 v222, v219, 0x40000000, v220
  v_fmamk_f32 v223, v219, 0x40400000, v220
  v_cos_f32 v224, v222
  v_sin_f32 v226, v222
  v_cos_f32 v225, v223
  v_sin_f32 v227, v223
  v_cvt_pk_f16_f32 v73, v224, v225
  v_cvt_pk_f16_f32 v75, v226, v227
  v_cmp_eq_u32 vcc, 8, v216
  v_mov_b32 v78, 0
  v_mov_b32 v79, 0
  v_mov_b32 v77, 0xbc003c00
  v_cndmask_b32 v76, v78, v77, vcc
  v_cndmask_b32 v77, v78, v77, vcc
  s_waitcnt lgkmcnt(2)
  v_mfma_f32_16x16x32_f16 v[136:139], v[24:27], v[40:43], 0
  v_mfma_f32_16x16x32_f16 v[140:143], v[24:27], v[48:51], 0
  v_mfma_f32_16x16x32_f16 v[144:147], v[24:27], v[44:47], 0
  v_mfma_f32_16x16x32_f16 v[148:151], v[24:27], v[52:55], 0
  ds_read_b32 v254, v7
  s_waitcnt lgkmcnt(1)
  v_mfma_f32_16x16x32_f16 v[152:155], v[28:31], v[40:43], 0
  v_mfma_f32_16x16x32_f16 v[156:159], v[28:31], v[48:51], 0
  v_mfma_f32_16x16x32_f16 v[160:163], v[28:31], v[44:47], 0
  v_mfma_f32_16x16x32_f16 v[164:167], v[28:31], v[52:55], 0
  v_pk_mul_f32 v[80:81], v[136:137], v[56:57]
  v_pk_mul_f32 v[84:85], v[140:141], v[56:57]
  v_pk_mul_f32 v[82:83], v[138:139], v[58:59]
  v_pk_mul_f32 v[86:87], v[142:143], v[58:59]
  v_pk_fma_f32 v[80:81], v[140:141], v[64:65], v[80:81]
  v_pk_fma_f32 v[84:85], v[136:137], v[64:65], v[84:85] neg_lo:[1,0,0] neg_hi:[1,0,0]
  v_pk_fma_f32 v[82:83], v[142:143], v[66:67], v[82:83]
  v_pk_fma_f32 v[86:87], v[138:139], v[66:67], v[86:87] neg_lo:[1,0,0] neg_hi:[1,0,0]
  v_cvt_pk_f16_f32 v176, v80, v81
  v_cvt_pk_f16_f32 v177, v82, v83
  v_cvt_pk_f16_f32 v178, v84, v85
  v_cvt_pk_f16_f32 v179, v86, v87
  v_pk_mul_f32 v[80:81], v[144:145], v[60:61]
  v_pk_mul_f32 v[84:85], v[148:149], v[60:61]
  v_pk_mul_f32 v[82:83], v[146:147], v[62:63]
  v_pk_mul_f32 v[86:87], v[150:151], v[62:63]
  v_pk_fma_f32 v[80:81], v[148:149], v[68:69], v[80:81]
  v_pk_fma_f32 v[84:85], v[144:145], v[68:69], v[84:85] neg_lo:[1,0,0] neg_hi:[1,0,0]
  v_pk_fma_f32 v[82:83], v[150:151], v[70:71], v[82:83]
  v_pk_fma_f32 v[86:87], v[146:147], v[70:71], v[86:87] neg_lo:[1,0,0] neg_hi:[1,0,0]
  v_cvt_pk_f16_f32 v180, v80, v81
  v_cvt_pk_f16_f32 v181, v82, v83
  v_cvt_pk_f16_f32 v182, v84, v85
  v_cvt_pk_f16_f32 v183, v86, v87
  v_pk_mul_f32 v[80:81], v[152:153], v[56:57]
  v_pk_mul_f32 v[84:85], v[156:157], v[56:57]
  v_pk_mul_f32 v[82:83], v[154:155], v[58:59]
  v_pk_mul_f32 v[86:87], v[158:159], v[58:59]
  v_pk_fma_f32 v[80:81], v[156:157], v[64:65], v[80:81]
  v_pk_fma_f32 v[84:85], v[152:153], v[64:65], v[84:85] neg_lo:[1,0,0] neg_hi:[1,0,0]
  v_pk_fma_f32 v[82:83], v[158:159], v[66:67], v[82:83]
  v_pk_fma_f32 v[86:87], v[154:155], v[66:67], v[86:87] neg_lo:[1,0,0] neg_hi:[1,0,0]
  v_cvt_pk_f16_f32 v184, v80, v81
  v_cvt_pk_f16_f32 v185, v82, v83
  v_cvt_pk_f16_f32 v186, v84, v85
  v_cvt_pk_f16_f32 v187, v86, v87
  v_pk_mul_f32 v[80:81], v[160:161], v[60:61]
  v_pk_mul_f32 v[84:85], v[164:165], v[60:61]
  v_pk_mul_f32 v[82:83], v[162:163], v[62:63]
  v_pk_mul_f32 v[86:87], v[166:167], v[62:63]
  v_pk_fma_f32 v[80:81], v[164:165], v[68:69], v[80:81]
  v_pk_fma_f32 v[84:85], v[160:161], v[68:69], v[84:85] neg_lo:[1,0,0] neg_hi:[1,0,0]
  v_pk_fma_f32 v[82:83], v[166:167], v[70:71], v[82:83]
  v_pk_fma_f32 v[86:87], v[162:163], v[70:71], v[86:87] neg_lo:[1,0,0] neg_hi:[1,0,0]
  v_cvt_pk_f16_f32 v188, v80, v81
  v_cvt_pk_f16_f32 v189, v82, v83
  v_cvt_pk_f16_f32 v190, v84, v85
  v_cvt_pk_f16_f32 v191, v86, v87
  v_mfma_f32_16x16x32_f16 v[208:211], v[76:79], v[176:179], 0
  v_mfma_f32_16x16x32_f16 v[192:195], v[72:75], v[176:179], 0
  v_mfma_f32_16x16x32_f16 v[196:199], v[72:75], v[180:183], 0
  v_mfma_f32_16x16x32_f16 v[212:215], v[76:79], v[184:187], 0
  v_mfma_f32_16x16x32_f16 v[200:203], v[72:75], v[184:187], 0
  v_mfma_f32_16x16x32_f16 v[204:207], v[72:75], v[188:191], 0
  s_nop 3
  v_cndmask_b32 v192, v192, v208, s[60:61]
  s_nop 1
  v_cndmask_b32 v200, v200, v212, s[60:61]
  v_cvt_pk_f16_f32 v80, v192, v200
  ds_write_b32 v132, v80 offset:0
  v_cvt_pk_f16_f32 v81, v193, v201
  ds_write_b32 v132, v81 offset:256
  v_cvt_pk_f16_f32 v82, v194, v202
  ds_write_b32 v132, v82 offset:512
  v_cvt_pk_f16_f32 v83, v195, v203
  ds_write_b32 v132, v83 offset:768
  v_cvt_pk_f16_f32 v84, v196, v204
  ds_write_b32 v132, v84 offset:128
  v_cvt_pk_f16_f32 v85, v197, v205
  ds_write_b32 v132, v85 offset:384
  v_cvt_pk_f16_f32 v86, v198, v206
  ds_write_b32 v132, v86 offset:640
  v_cvt_pk_f16_f32 v87, v199, v207
  ds_write_b32 v132, v87 offset:896
  ds_read_b32 v254, v7
  s_waitcnt lgkmcnt(1)
  s_barrier
  ds_read2st64_b32 v[80:81], v133 offset0:0 offset1:8
  ds_read2st64_b32 v[82:83], v133 offset0:16 offset1:24
  ds_read2st64_b32 v[84:85], v133 offset0:1 offset1:9
  ds_read2st64_b32 v[86:87], v133 offset0:17 offset1:25
  s_waitcnt lgkmcnt(2)
  buffer_store_dwordx4 v[80:83], v7, s[16:19], s77 offen offset:0 sc1
  ds_read_b32 v254, v7
  s_waitcnt lgkmcnt(1)
  buffer_store_dwordx4 v[84:87], v7, s[16:19], s77 offen offset:1024 sc1
  s_lshr_b32 s50, s39, 3
  s_lshl_b32 s50, s50, 8
  s_lshl_b32 s51, s3, 6
  s_add_u32 s50, s50, s51
  s_mul_i32 s50, s50, 16
  s_add_u32 s50, s50, 8912896
  v_mul_u32_u24 v10, 16, v0
  v_add_u32 v10, s50, v10
  v_lshrrev_b32 v11, 5, v0
  v_lshrrev_b32 v12, 4, v0
  v_xor_b32 v13, v12, v0
  v_and_b32 v13, 15, v13
  v_lshlrev_b32 v12, 13, v12
  v_lshl_add_u32 v242, v13, 4, v12
  v_bfe_u32 v12, v0, 2, 2
  v_mul_u32_u24 v240, 2112, v12
  v_lshl_add_u32 v240, v11, 15, v240
  v_bfe_u32 v12, v0, 4, 1
  v_bfe_u32 v13, v0, 1, 1
  v_lshl_add_u32 v12, v12, 1, v13
  v_mul_u32_u24 v12, 272, v12
  v_and_b32 v13, 1, v0
  v_lshl_add_u32 v12, v13, 3, v12
  s_lshl_b32 s50, s3, 6
  v_add_u32 v240, v240, v12
  v_xor_b32 v240, s50, v240
  v_add_u32 v240, 49152, v240
  v_and_b32 v12, 31, v0
  v_lshlrev_b32 v244, 2, v12
  v_lshl_add_u32 v244, v11, 10, v244
  s_lshl_b32 s50, s3, 13
  v_add_u32 v244, s50, v244
  s_lshl_b32 s50, s3, 11
  v_lshl_add_u32 v245, v0, 2, s50
  s_lshl2_add_u32 s50, s39, s3
  s_mul_i32 s50, s50, 16
  s_add_u32 s100, s50, 10223616
  s_waitcnt vmcnt(0)
  s_atomic_swap s32, s[16:17], s99
  v_cvt_f32_u32 v12, v12
  v_cvt_f32_u32 v11, v11
  s_lshl_b32 s50, s64, 16
  s_add_u32 s40, s41, s50
  buffer_load_dword v255, v253, s[12:15], s76 offen
  s_add_u32 s76, s76, 262144
  v_mul_f32 v13, 0x3d000000, v12
  v_mul_f32 v14, v13, v11
  v_mul_f32 v14, 0x41000000, v14
  v_fmamk_f32 v233, v13, 0x3f800000, v14
  v_cos_f32 v234, v14
  v_sin_f32 v236, v14
  v_cos_f32 v235, v233
  v_sin_f32 v237, v233
  v_cvt_pk_f16_f32 v234, v234, v235
  v_cvt_pk_f16_f32 v236, v236, v237
  v_accvgpr_write_b32 a128, v234
  v_accvgpr_write_b32 a136, v236
  v_xor_b32 v236, 0x80008000, v236
  v_accvgpr_write_b32 a144, v236
  v_fmamk_f32 v232, v13, 0x40000000, v14
  v_fmamk_f32 v233, v13, 0x40400000, v14
  v_cos_f32 v234, v232
  v_sin_f32 v236, v232
  v_cos_f32 v235, v233
  v_sin_f32 v237, v233
  v_cvt_pk_f16_f32 v234, v234, v235
  v_cvt_pk_f16_f32 v236, v236, v237
  v_accvgpr_write_b32 a129, v234
  v_accvgpr_write_b32 a137, v236
  v_xor_b32 v236, 0x80008000, v236
  v_accvgpr_write_b32 a145, v236
  v_fmamk_f32 v232, v13, 0x40800000, v14
  v_fmamk_f32 v233, v13, 0x40a00000, v14
  v_cos_f32 v234, v232
  v_sin_f32 v236, v232
  v_cos_f32 v235, v233
  v_sin_f32 v237, v233
  v_cvt_pk_f16_f32 v234, v234, v235
  v_cvt_pk_f16_f32 v236, v236, v237
  v_accvgpr_write_b32 a130, v234
  v_accvgpr_write_b32 a138, v236
  v_xor_b32 v236, 0x80008000, v236
  v_accvgpr_write_b32 a146, v236
  v_fmamk_f32 v232, v13, 0x40c00000, v14
  v_fmamk_f32 v233, v13, 0x40e00000, v14
  v_cos_f32 v234, v232
  v_sin_f32 v236, v232
  v_cos_f32 v235, v233
  v_sin_f32 v237, v233
  v_cvt_pk_f16_f32 v234, v234, v235
  v_cvt_pk_f16_f32 v236, v236, v237
  v_accvgpr_write_b32 a131, v234
  v_accvgpr_write_b32 a139, v236
  v_xor_b32 v236, 0x80008000, v236
  v_accvgpr_write_b32 a147, v236
  v_fmamk_f32 v232, v13, 0x41800000, v14
  v_fmamk_f32 v233, v13, 0x41880000, v14
  v_cos_f32 v234, v232
  v_sin_f32 v236, v232
  v_cos_f32 v235, v233
  v_sin_f32 v237, v233
  v_cvt_pk_f16_f32 v234, v234, v235
  v_cvt_pk_f16_f32 v236, v236, v237
  v_accvgpr_write_b32 a132, v234
  v_accvgpr_write_b32 a140, v236
  v_xor_b32 v236, 0x80008000, v236
  v_accvgpr_write_b32 a148, v236
  v_fmamk_f32 v232, v13, 0x41900000, v14
  v_fmamk_f32 v233, v13, 0x41980000, v14
  v_cos_f32 v234, v232
  v_sin_f32 v236, v232
  v_cos_f32 v235, v233
  v_sin_f32 v237, v233
  v_cvt_pk_f16_f32 v234, v234, v235
  v_cvt_pk_f16_f32 v236, v236, v237
  v_accvgpr_write_b32 a133, v234
  v_accvgpr_write_b32 a141, v236
  v_xor_b32 v236, 0x80008000, v236
  v_accvgpr_write_b32 a149, v236
  v_fmamk_f32 v232, v13, 0x41a00000, v14
  v_fmamk_f32 v233, v13, 0x41a80000, v14
  v_cos_f32 v234, v232
  v_sin_f32 v236, v232
  v_cos_f32 v235, v233
  v_sin_f32 v237, v233
  v_cvt_pk_f16_f32 v234, v234, v235
  v_cvt_pk_f16_f32 v236, v236, v237
  v_accvgpr_write_b32 a134, v234
  v_accvgpr_write_b32 a142, v236
  v_xor_b32 v236, 0x80008000, v236
  v_accvgpr_write_b32 a150, v236
  v_fmamk_f32 v232, v13, 0x41b00000, v14
  v_fmamk_f32 v233, v13, 0x41b80000, v14
  v_cos_f32 v234, v232
  v_sin_f32 v236, v232
  v_cos_f32 v235, v233
  v_sin_f32 v237, v233
  v_cvt_pk_f16_f32 v234, v234, v235
  v_cvt_pk_f16_f32 v236, v236, v237
  v_accvgpr_write_b32 a135, v234
  v_accvgpr_write_b32 a143, v236
  v_xor_b32 v236, 0x80008000, v236
  v_accvgpr_write_b32 a151, v236
  v_mul_f32 v13, 0x3a000000, v12
  v_mul_f32 v14, v13, v11
  v_mul_f32 v14, 4.0, v14
  v_fmamk_f32 v233, v13, 0x3f800000, v14
  v_cos_f32 v234, v14
  v_sin_f32 v236, v14
  v_cos_f32 v235, v233
  v_sin_f32 v237, v233
  v_cvt_pk_f16_f32 v16, v234, v235
  v_cvt_pk_f16_f32 v32, v236, v237
  v_fmamk_f32 v232, v13, 0x40000000, v14
  v_fmamk_f32 v233, v13, 0x40400000, v14
  v_cos_f32 v234, v232
  v_sin_f32 v236, v232
  v_cos_f32 v235, v233
  v_sin_f32 v237, v233
  v_cvt_pk_f16_f32 v17, v234, v235
  v_cvt_pk_f16_f32 v33, v236, v237
  v_fmamk_f32 v232, v13, 0x41000000, v14
  v_fmamk_f32 v233, v13, 0x41100000, v14
  v_cos_f32 v234, v232
  v_sin_f32 v236, v232
  v_cos_f32 v235, v233
  v_sin_f32 v237, v233
  v_cvt_pk_f16_f32 v18, v234, v235
  v_cvt_pk_f16_f32 v34, v236, v237
  v_fmamk_f32 v232, v13, 0x41200000, v14
  v_fmamk_f32 v233, v13, 0x41300000, v14
  v_cos_f32 v234, v232
  v_sin_f32 v236, v232
  v_cos_f32 v235, v233
  v_sin_f32 v237, v233
  v_cvt_pk_f16_f32 v19, v234, v235
  v_cvt_pk_f16_f32 v35, v236, v237
  v_fmamk_f32 v232, v13, 0x41800000, v14
  v_fmamk_f32 v233, v13, 0x41880000, v14
  v_cos_f32 v234, v232
  v_sin_f32 v236, v232
  v_cos_f32 v235, v233
  v_sin_f32 v237, v233
  v_cvt_pk_f16_f32 v20, v234, v235
  v_cvt_pk_f16_f32 v36, v236, v237
  v_fmamk_f32 v232, v13, 0x41900000, v14
  v_fmamk_f32 v233, v13, 0x41980000, v14
  v_cos_f32 v234, v232
  v_sin_f32 v236, v232
  v_cos_f32 v235, v233
  v_sin_f32 v237, v233
  v_cvt_pk_f16_f32 v21, v234, v235
  v_cvt_pk_f16_f32 v37, v236, v237
  v_fmamk_f32 v232, v13, 0x41c00000, v14
  v_fmamk_f32 v233, v13, 0x41c80000, v14
  v_cos_f32 v234, v232
  v_sin_f32 v236, v232
  v_cos_f32 v235, v233
  v_sin_f32 v237, v233
  v_cvt_pk_f16_f32 v22, v234, v235
  v_cvt_pk_f16_f32 v38, v236, v237
  v_fmamk_f32 v232, v13, 0x41d00000, v14
  v_fmamk_f32 v233, v13, 0x41d80000, v14
  v_cos_f32 v234, v232
  v_sin_f32 v236, v232
  v_cos_f32 v235, v233
  v_sin_f32 v237, v233
  v_cvt_pk_f16_f32 v23, v234, v235
  v_cvt_pk_f16_f32 v39, v236, v237
  v_fmamk_f32 v232, v13, 0x42000000, v14
  v_fmamk_f32 v233, v13, 0x42040000, v14
  v_cos_f32 v234, v232
  v_sin_f32 v236, v232
  v_cos_f32 v235, v233
  v_sin_f32 v237, v233
  v_cvt_pk_f16_f32 v24, v234, v235
  v_cvt_pk_f16_f32 v40, v236, v237
  v_fmamk_f32 v232, v13, 0x42080000, v14
  v_fmamk_f32 v233, v13, 0x420c0000, v14
  v_cos_f32 v234, v232
  v_sin_f32 v236, v232
  v_cos_f32 v235, v233
  v_sin_f32 v237, v233
  v_cvt_pk_f16_f32 v25, v234, v235
  v_cvt_pk_f16_f32 v41, v236, v237
  v_fmamk_f32 v232, v13, 0x42200000, v14
  v_fmamk_f32 v233, v13, 0x42240000, v14
  v_cos_f32 v234, v232
  v_sin_f32 v236, v232
  v_cos_f32 v235, v233
  v_sin_f32 v237, v233
  v_cvt_pk_f16_f32 v26, v234, v235
  v_cvt_pk_f16_f32 v42, v236, v237
  v_fmamk_f32 v232, v13, 0x42280000, v14
  v_fmamk_f32 v233, v13, 0x422c0000, v14
  v_cos_f32 v234, v232
  v_sin_f32 v236, v232
  v_cos_f32 v235, v233
  v_sin_f32 v237, v233
  v_cvt_pk_f16_f32 v27, v234, v235
  v_cvt_pk_f16_f32 v43, v236, v237
  v_fmamk_f32 v232, v13, 0x42400000, v14
  v_fmamk_f32 v233, v13, 0x42440000, v14
  v_cos_f32 v234, v232
  v_sin_f32 v236, v232
  v_cos_f32 v235, v233
  v_sin_f32 v237, v233
  v_cvt_pk_f16_f32 v28, v234, v235
  v_cvt_pk_f16_f32 v44, v236, v237
  v_fmamk_f32 v232, v13, 0x42480000, v14
  v_fmamk_f32 v233, v13, 0x424c0000, v14
  v_cos_f32 v234, v232
  v_sin_f32 v236, v232
  v_cos_f32 v235, v233
  v_sin_f32 v237, v233
  v_cvt_pk_f16_f32 v29, v234, v235
  v_cvt_pk_f16_f32 v45, v236, v237
  v_fmamk_f32 v232, v13, 0x42600000, v14
  v_fmamk_f32 v233, v13, 0x42640000, v14
  v_cos_f32 v234, v232
  v_sin_f32 v236, v232
  v_cos_f32 v235, v233
  v_sin_f32 v237, v233
  v_cvt_pk_f16_f32 v30, v234, v235
  v_cvt_pk_f16_f32 v46, v236, v237
  v_fmamk_f32 v232, v13, 0x42680000, v14
  v_fmamk_f32 v233, v13, 0x426c0000, v14
  v_cos_f32 v234, v232
  v_sin_f32 v236, v232
  v_cos_f32 v235, v233
  v_sin_f32 v237, v233
  v_cvt_pk_f16_f32 v31, v234, v235
  v_cvt_pk_f16_f32 v47, v236, v237
  v_fma_f32 v13, v12, 2.0, 0
  v_mul_f32 v13, 0x3c800000, v13
  v_mul_f32 v14, v13, v11
  v_mul_f32 v14, 4.0, v14
  v_fmamk_f32 v233, v13, 0x3f800000, v14
  v_cos_f32 v234, v14
  v_sin_f32 v236, v14
  v_cos_f32 v235, v233
  v_sin_f32 v237, v233
  v_cvt_pk_f16_f32 v234, v234, v235
  v_cvt_pk_f16_f32 v236, v236, v237
  v_accvgpr_write_b32 a152, v234
  v_accvgpr_write_b32 a168, v236
  v_fmamk_f32 v232, v13, 0x40000000, v14
  v_fmamk_f32 v233, v13, 0x40400000, v14
  v_cos_f32 v234, v232
  v_sin_f32 v236, v232
  v_cos_f32 v235, v233
  v_sin_f32 v237, v233
  v_cvt_pk_f16_f32 v234, v234, v235
  v_cvt_pk_f16_f32 v236, v236, v237
  v_accvgpr_write_b32 a153, v234
  v_accvgpr_write_b32 a169, v236
  v_fmamk_f32 v232, v13, 0x41000000, v14
  v_fmamk_f32 v233, v13, 0x41100000, v14
  v_cos_f32 v234, v232
  v_sin_f32 v236, v232
  v_cos_f32 v235, v233
  v_sin_f32 v237, v233
  v_cvt_pk_f16_f32 v234, v234, v235
  v_cvt_pk_f16_f32 v236, v236, v237
  v_accvgpr_write_b32 a154, v234
  v_accvgpr_write_b32 a170, v236
  v_fmamk_f32 v232, v13, 0x41200000, v14
  v_fmamk_f32 v233, v13, 0x41300000, v14
  v_cos_f32 v234, v232
  v_sin_f32 v236, v232
  v_cos_f32 v235, v233
  v_sin_f32 v237, v233
  v_cvt_pk_f16_f32 v234, v234, v235
  v_cvt_pk_f16_f32 v236, v236, v237
  v_accvgpr_write_b32 a155, v234
  v_accvgpr_write_b32 a171, v236
  v_fmamk_f32 v232, v13, 0x41800000, v14
  v_fmamk_f32 v233, v13, 0x41880000, v14
  v_cos_f32 v234, v232
  v_sin_f32 v236, v232
  v_cos_f32 v235, v233
  v_sin_f32 v237, v233
  v_cvt_pk_f16_f32 v234, v234, v235
  v_cvt_pk_f16_f32 v236, v236, v237
  v_accvgpr_write_b32 a156, v234
  v_accvgpr_write_b32 a172, v236
  v_fmamk_f32 v232, v13, 0x41900000, v14
  v_fmamk_f32 v233, v13, 0x41980000, v14
  v_cos_f32 v234, v232
  v_sin_f32 v236, v232
  v_cos_f32 v235, v233
  v_sin_f32 v237, v233
  v_cvt_pk_f16_f32 v234, v234, v235
  v_cvt_pk_f16_f32 v236, v236, v237
  v_accvgpr_write_b32 a157, v234
  v_accvgpr_write_b32 a173, v236
  v_fmamk_f32 v232, v13, 0x41c00000, v14
  v_fmamk_f32 v233, v13, 0x41c80000, v14
  v_cos_f32 v234, v232
  v_sin_f32 v236, v232
  v_cos_f32 v235, v233
  v_sin_f32 v237, v233
  v_cvt_pk_f16_f32 v234, v234, v235
  v_cvt_pk_f16_f32 v236, v236, v237
  v_accvgpr_write_b32 a158, v234
  v_accvgpr_write_b32 a174, v236
  v_fmamk_f32 v232, v13, 0x41d00000, v14
  v_fmamk_f32 v233, v13, 0x41d80000, v14
  v_cos_f32 v234, v232
  v_sin_f32 v236, v232
  v_cos_f32 v235, v233
  v_sin_f32 v237, v233
  v_cvt_pk_f16_f32 v234, v234, v235
  v_cvt_pk_f16_f32 v236, v236, v237
  v_accvgpr_write_b32 a159, v234
  v_accvgpr_write_b32 a175, v236
  v_fma_f32 v13, v12, 2.0, 1.0
  v_mul_f32 v13, 0x3c800000, v13
  v_mul_f32 v14, v13, v11
  v_mul_f32 v14, 4.0, v14
  v_fmamk_f32 v233, v13, 0x3f800000, v14
  v_cos_f32 v234, v14
  v_sin_f32 v236, v14
  v_cos_f32 v235, v233
  v_sin_f32 v237, v233
  v_cvt_pk_f16_f32 v234, v234, v235
  v_cvt_pk_f16_f32 v236, v236, v237
  v_accvgpr_write_b32 a160, v234
  v_accvgpr_write_b32 a176, v236
  v_fmamk_f32 v232, v13, 0x40000000, v14
  v_fmamk_f32 v233, v13, 0x40400000, v14
  v_cos_f32 v234, v232
  v_sin_f32 v236, v232
  v_cos_f32 v235, v233
  v_sin_f32 v237, v233
  v_cvt_pk_f16_f32 v234, v234, v235
  v_cvt_pk_f16_f32 v236, v236, v237
  v_accvgpr_write_b32 a161, v234
  v_accvgpr_write_b32 a177, v236
  v_fmamk_f32 v232, v13, 0x41000000, v14
  v_fmamk_f32 v233, v13, 0x41100000, v14
  v_cos_f32 v234, v232
  v_sin_f32 v236, v232
  v_cos_f32 v235, v233
  v_sin_f32 v237, v233
  v_cvt_pk_f16_f32 v234, v234, v235
  v_cvt_pk_f16_f32 v236, v236, v237
  v_accvgpr_write_b32 a162, v234
  v_accvgpr_write_b32 a178, v236
  v_fmamk_f32 v232, v13, 0x41200000, v14
  v_fmamk_f32 v233, v13, 0x41300000, v14
  v_cos_f32 v234, v232
  v_sin_f32 v236, v232
  v_cos_f32 v235, v233
  v_sin_f32 v237, v233
  v_cvt_pk_f16_f32 v234, v234, v235
  v_cvt_pk_f16_f32 v236, v236, v237
  v_accvgpr_write_b32 a163, v234
  v_accvgpr_write_b32 a179, v236
  buffer_load_dword v9, v10, s[16:19], 0 offen sc1
  v_fmamk_f32 v232, v13, 0x41800000, v14
  v_fmamk_f32 v233, v13, 0x41880000, v14
  v_cos_f32 v234, v232
  v_sin_f32 v236, v232
  v_cos_f32 v235, v233
  v_sin_f32 v237, v233
  v_cvt_pk_f16_f32 v234, v234, v235
  v_cvt_pk_f16_f32 v236, v236, v237
  v_accvgpr_write_b32 a164, v234
  v_accvgpr_write_b32 a180, v236
  v_fmamk_f32 v232, v13, 0x41900000, v14
  v_fmamk_f32 v233, v13, 0x41980000, v14
  v_cos_f32 v234, v232
  v_sin_f32 v236, v232
  v_cos_f32 v235, v233
  v_sin_f32 v237, v233
  v_cvt_pk_f16_f32 v234, v234, v235
  v_cvt_pk_f16_f32 v236, v236, v237
  v_accvgpr_write_b32 a165, v234
  v_accvgpr_write_b32 a181, v236
  v_fmamk_f32 v232, v13, 0x41c00000, v14
  v_fmamk_f32 v233, v13, 0x41c80000, v14
  v_cos_f32 v234, v232
  v_sin_f32 v236, v232
  v_cos_f32 v235, v233
  v_sin_f32 v237, v233
  v_cvt_pk_f16_f32 v234, v234, v235
  v_cvt_pk_f16_f32 v236, v236, v237
  v_accvgpr_write_b32 a166, v234
  v_accvgpr_write_b32 a182, v236
  v_fmamk_f32 v232, v13, 0x41d00000, v14
  v_fmamk_f32 v233, v13, 0x41d80000, v14
  v_cos_f32 v234, v232
  v_sin_f32 v236, v232
  v_cos_f32 v235, v233
  v_sin_f32 v237, v233
  v_cvt_pk_f16_f32 v234, v234, v235
  v_cvt_pk_f16_f32 v236, v236, v237
  v_accvgpr_write_b32 a167, v234
  v_accvgpr_write_b32 a183, v236
  s_waitcnt vmcnt(0)
  v_cmp_ne_u32 vcc, s32, v9
  s_cbranch_vccz L13_ok
L14_retry:
  buffer_load_dword v9, v10, s[16:19], 0 offen sc1
  s_add_u32 s62, s62, 1
  s_cmp_gt_u32 s62, 200000
  s_waitcnt vmcnt(0)
  s_cbranch_scc1 L13_ok
  v_cmp_ne_u32 vcc, s32, v9
  s_cbranch_vccnz L14_retry
L13_ok:
  s_lshl_b32 s50, s39, 8
  s_lshl_b32 s51, s3, 19
  s_add_u32 s50, s50, s51
  s_add_u32 s50, s50, 2097152
  s_add_u32 m0, s47, 16384
  s_nop 0
  buffer_load_dwordx4 v242, s[16:19], s50 offen sc1 lds
  s_add_u32 m0, m0, s48
  s_add_u32 s50, s50, 32768
  buffer_load_dwordx4 v242, s[16:19], s50 offen sc1 lds
  s_add_u32 m0, m0, s48
  s_add_u32 s50, s50, 32768
  v_xor_b32 v243, 64, v242
  buffer_load_dwordx4 v243, s[16:19], s50 offen sc1 lds
  s_add_u32 m0, m0, s48
  s_add_u32 s50, s50, 32768
  buffer_load_dwordx4 v243, s[16:19], s50 offen sc1 lds
  s_add_u32 m0, m0, s48
  s_add_u32 s50, s50, 32768
  v_xor_b32 v243, 128, v242
  buffer_load_dwordx4 v243, s[16:19], s50 offen sc1 lds
  s_add_u32 m0, m0, s48
  s_add_u32 s50, s50, 32768
  buffer_load_dwordx4 v243, s[16:19], s50 offen sc1 lds
  s_add_u32 m0, m0, s48
  s_add_u32 s50, s50, 32768
  v_xor_b32 v243, 192, v242
  buffer_load_dwordx4 v243, s[16:19], s50 offen sc1 lds
  s_add_u32 m0, m0, s48
  s_add_u32 s50, s50, 32768
  buffer_load_dwordx4 v243, s[16:19], s50 offen sc1 lds
  s_add_u32 m0, m0, s48
  s_add_u32 s50, s50, 32768
  buffer_load_dwordx4 v242, s[16:19], s50 offen sc1 lds
  s_add_u32 m0, m0, s48
  s_add_u32 s50, s50, 32768
  buffer_load_dwordx4 v242, s[16:19], s50 offen sc1 lds
  s_add_u32 m0, m0, s48
  s_add_u32 s50, s50, 32768
  v_xor_b32 v243, 64, v242
  buffer_load_dwordx4 v243, s[16:19], s50 offen sc1 lds
  s_add_u32 m0, m0, s48
  s_add_u32 s50, s50, 32768
  buffer_load_dwordx4 v243, s[16:19], s50 offen sc1 lds
  s_add_u32 m0, m0, s48
  s_add_u32 s50, s50, 32768
  v_xor_b32 v243, 128, v242
  buffer_load_dwordx4 v243, s[16:19], s50 offen sc1 lds
  s_add_u32 m0, m0, s48
  s_add_u32 s50, s50, 32768
  buffer_load_dwordx4 v243, s[16:19], s50 offen sc1 lds
  s_add_u32 m0, m0, s48
  s_add_u32 s50, s50, 32768
  v_xor_b32 v243, 192, v242
  buffer_load_dwordx4 v243, s[16:19], s50 offen sc1 lds
  s_add_u32 m0, m0, s48
  s_add_u32 s50, s50, 32768
  buffer_load_dwordx4 v243, s[16:19], s50 offen sc1 lds
  s_waitcnt vmcnt(0)
  s_barrier
  s_or_b32 s50, s39, s3
  s_cmp_eq_u32 s50, 0
  s_cselect_b32 s78, 1, 0
  s_cbranch_scc0 L15_no_nonce
  s_mov_b32 s50, 7405568
  s_atomic_swap s32, s[16:17], s50
L15_no_nonce:
  buffer_load_dword v255, v253, s[12:15], s76 offen
  s_add_u32 s76, s76, 262144
  s_lshr_b32 s50, s12, 7
  s_sub_u32 s50, 3, s50
  s_and_b32 s50, s50, 7
  s_and_b32 s51, s37, 24
  s_add_u32 s50, s50, s51
  s_lshl_b32 s50, s50, 7
  s_lshl2_add_u32 s51, s34, s3
  s_mul_i32 s51, s51, 57344
  s_add_u32 s50, s50, s51
  v_min_u32 v253, 13, v0
  v_lshlrev_b32 v253, 12, v253
  buffer_load_dword v255, v253, s[12:15], s50 offen
  v_min_u32 v253, 31, v0
  v_lshlrev_b32 v253, 12, v253
  s_mul_i32 s50, s38, 131072
  s_add_u32 s50, s50, 786432
  s_mul_i32 s51, s3, 1835008
  s_add_u32 s50, s50, s51
  s_lshl_b32 s51, s37, 7
  s_add_u32 s50, s50, s51
  buffer_load_dword v255, v253, s[12:15], s50 offen
  v_xor_b32 v232, 0, v240
  v_add_u32 v233, 0x10000, v232
  v_xor_b32 v234, 16, v240
  v_add_u32 v235, 0x10000, v234
  ds_read_b64_tr_b16 a[192:193], v232 offset:0
  ds_read_b64_tr_b16 a[194:195], v232 offset:8192
  ds_read_b64_tr_b16 a[200:201], v234 offset:0
  ds_read_b64_tr_b16 a[202:203], v234 offset:8192
  ds_read_b64_tr_b16 a[196:197], v233 offset:0
  ds_read_b64_tr_b16 a[198:199], v233 offset:8192
  ds_read_b64_tr_b16 a[204:205], v235 offset:0
  ds_read_b64_tr_b16 a[206:207], v235 offset:8192
  ds_read_b64_tr_b16 a[208:209], v232 offset:1024
  ds_read_b64_tr_b16 a[210:211], v232 offset:9216
  ds_read_b64_tr_b16 a[216:217], v234 offset:1024
  ds_read_b64_tr_b16 a[218:219], v234 offset:9216
  ds_read_b64_tr_b16 a[212:213], v233 offset:1024
  ds_read_b64_tr_b16 a[214:215], v233 offset:9216
  ds_read_b64_tr_b16 a[220:221], v235 offset:1024
  ds_read_b64_tr_b16 a[222:223], v235 offset:9216
  s_cmp_eq_u32 s78, 0
  s_cbranch_scc1 L16_keep_im
  s_waitcnt lgkmcnt(0)
  v_accvgpr_write_b32 a200, 0
  v_accvgpr_write_b32 a201, 0
  v_accvgpr_write_b32 a202, 0
  v_accvgpr_write_b32 a203, 0
  v_accvgpr_write_b32 a204, 0
  v_accvgpr_write_b32 a205, 0
  v_accvgpr_write_b32 a206, 0
  v_accvgpr_write_b32 a207, 0
  v_accvgpr_write_b32 a216, 0
  v_accvgpr_write_b32 a217, 0
  v_accvgpr_write_b32 a218, 0
  v_accvgpr_write_b32 a219, 0
  v_accvgpr_write_b32 a220, 0
  v_accvgpr_write_b32 a221, 0
  v_accvgpr_write_b32 a222, 0
  v_accvgpr_write_b32 a223, 0
L16_keep_im:
  v_xor_b32 v232, 32, v240
  v_add_u32 v233, 0x10000, v232
  v_xor_b32 v234, 48, v240
  v_add_u32 v235, 0x10000, v234
  ds_read_b64_tr_b16 a[224:225], v232 offset:0
  ds_read_b64_tr_b16 a[226:227], v232 offset:8192
  ds_read_b64_tr_b16 a[232:233], v234 offset:0
  ds_read_b64_tr_b16 a[234:235], v234 offset:8192
  ds_read_b64_tr_b16 a[228:229], v233 offset:0
  ds_read_b64_tr_b16 a[230:231], v233 offset:8192
  ds_read_b64_tr_b16 a[236:237], v235 offset:0
  ds_read_b64_tr_b16 a[238:239], v235 offset:8192
  ds_read_b64_tr_b16 a[240:241], v232 offset:1024
  ds_read_b64_tr_b16 a[242:243], v232 offset:9216
  ds_read_b64_tr_b16 a[248:249], v234 offset:1024
  ds_read_b64_tr_b16 a[250:251], v234 offset:9216
  ds_read_b64_tr_b16 a[244:245], v233 offset:1024
  ds_read_b64_tr_b16 a[246:247], v233 offset:9216
  ds_read_b64_tr_b16 a[252:253], v235 offset:1024
  ds_read_b64_tr_b16 a[254:255], v235 offset:9216
  s_waitcnt lgkmcnt(15)
  v_mfma_f32_32x32x16_f16 v[48:63], a[192:195], a[128:131], 0
  v_mfma_f32_32x32x16_f16 v[64:79], a[200:203], a[128:131], 0
  v_mfma_f32_32x32x16_f16 v[48:63], a[200:203], a[136:139], v[48:63]
  v_mfma_f32_32x32x16_f16 v[64:79], a[192:195], a[144:147], v[64:79]
  v_mfma_f32_32x32x16_f16 v[48:63], a[196:199], a[132:135], v[48:63]
  v_mfma_f32_32x32x16_f16 v[64:79], a[204:207], a[132:135], v[64:79]
  v_mfma_f32_32x32x16_f16 v[48:63], a[204:207], a[140:143], v[48:63]
  v_mfma_f32_32x32x16_f16 v[64:79], a[196:199], a[148:151], v[64:79]
  v_mfma_f32_32x32x16_f16 v[80:95], a[208:211], a[128:131], 0
  v_mfma_f32_32x32x16_f16 v[96:111], a[216:219], a[128:131], 0
  v_mfma_f32_32x32x16_f16 v[80:95], a[216:219], a[136:139], v[80:95]
  s_nop 7
  v_cvt_pk_f16_f32 v48, v48, v49
  v_cvt_pk_f16_f32 v49, v50, v51
  v_cvt_pk_f16_f32 v50, v52, v53
  v_cvt_pk_f16_f32 v51, v54, v55
  v_cvt_pk_f16_f32 v52, v56, v57
  v_cvt_pk_f16_f32 v53, v58, v59
  v_mfma_f32_32x32x16_f16 v[96:111], a[208:211], a[144:147], v[96:111]
  v_cvt_pk_f16_f32 v54, v60, v61
  v_cvt_pk_f16_f32 v55, v62, v63
  v_cvt_pk_f16_f32 v64, v64, v65
  v_cvt_pk_f16_f32 v65, v66, v67
  v_cvt_pk_f16_f32 v66, v68, v69
  v_cvt_pk_f16_f32 v67, v70, v71
  v_mfma_f32_32x32x16_f16 v[80:95], a[212:215], a[132:135], v[80:95]
  v_cvt_pk_f16_f32 v68, v72, v73
  v_cvt_pk_f16_f32 v69, v74, v75
  v_cvt_pk_f16_f32 v70, v76, v77
  v_cvt_pk_f16_f32 v71, v78, v79
  v_pk_mul_f16 v56, v48, v16
  v_pk_mul_f16 v72, v64, v16
  v_mfma_f32_32x32x16_f16 v[96:111], a[220:223], a[132:135], v[96:111]
  v_pk_mul_f16 v57, v49, v17
  v_pk_mul_f16 v73, v65, v17
  v_pk_mul_f16 v58, v50, v18
  v_pk_mul_f16 v74, v66, v18
  v_pk_mul_f16 v59, v51, v19
  v_pk_mul_f16 v75, v67, v19
  v_mfma_f32_32x32x16_f16 v[80:95], a[220:223], a[140:143], v[80:95]
  v_pk_mul_f16 v60, v52, v20
  v_pk_mul_f16 v76, v68, v20
  v_pk_mul_f16 v61, v53, v21
  v_pk_mul_f16 v77, v69, v21
  v_pk_mul_f16 v62, v54, v22
  v_pk_mul_f16 v78, v70, v22
  v_mfma_f32_32x32x16_f16 v[96:111], a[212:215], a[148:151], v[96:111]
  v_pk_mul_f16 v63, v55, v23
  v_pk_mul_f16 v79, v71, v23
  v_pk_fma_f16 v56, v64, v32, v56
  v_pk_fma_f16 v72, v48, v32, v72 neg_lo:[1,0,0] neg_hi:[1,0,0]
  v_pk_fma_f16 v57, v65, v33, v57
  v_pk_fma_f16 v73, v49, v33, v73 neg_lo:[1,0,0] neg_hi:[1,0,0]
  s_waitcnt lgkmcnt(12)
  v_mfma_f32_32x32x16_f16 v[112:127], a[224:227], a[128:131], 0
  v_pk_fma_f16 v58, v66, v34, v58
  v_pk_fma_f16 v74, v50, v34, v74 neg_lo:[1,0,0] neg_hi:[1,0,0]
  v_pk_fma_f16 v59, v67, v35, v59
  v_pk_fma_f16 v75, v51, v35, v75 neg_lo:[1,0,0] neg_hi:[1,0,0]
  v_pk_fma_f16 v60, v68, v36, v60
  v_pk_fma_f16 v76, v52, v36, v76 neg_lo:[1,0,0] neg_hi:[1,0,0]
  v_mfma_f32_32x32x16_f16 v[128:143], a[232:235], a[128:131], 0
  s_mov_b32 m0, s47
  s_nop 0
  buffer_load_dwordx4 v1, s[12:15], s40 offen lds
  buffer_load_dwordx4 v2, s[12:15], s40 offen offset:1024 lds
  s_add_u32 s40, s40, s43
  v_pk_fma_f16 v61, v69, v37, v61
  v_pk_fma_f16 v77, v53, v37, v77 neg_lo:[1,0,0] neg_hi:[1,0,0]
  v_pk_fma_f16 v62, v70, v38, v62
  v_pk_fma_f16 v78, v54, v38, v78 neg_lo:[1,0,0] neg_hi:[1,0,0]
  v_pk_fma_f16 v63, v71, v39, v63
  v_pk_fma_f16 v79, v55, v39, v79 neg_lo:[1,0,0] neg_hi:[1,0,0]
  v_mfma_f32_32x32x16_f16 v[112:127], a[232:235], a[136:139], v[112:127]
  v_cvt_pk_f16_f32 v80, v80, v81
  v_cvt_pk_f16_f32 v81, v82, v83
  v_cvt_pk_f16_f32 v82, v84, v85
  v_cvt_pk_f16_f32 v83, v86, v87
  v_cvt_pk_f16_f32 v84, v88, v89
  v_cvt_pk_f16_f32 v85, v90, v91
  v_mfma_f32_32x32x16_f16 v[128:143], a[224:227], a[144:147], v[128:143]
  v_cvt_pk_f16_f32 v86, v92, v93
  v_cvt_pk_f16_f32 v87, v94, v95
  v_cvt_pk_f16_f32 v96, v96, v97
  v_cvt_pk_f16_f32 v97, v98, v99
  v_cvt_pk_f16_f32 v98, v100, v101
  v_cvt_pk_f16_f32 v99, v102, v103
  s_waitcnt lgkmcnt(8)
  v_mfma_f32_32x32x16_f16 v[112:127], a[228:231], a[132:135], v[112:127]
  v_cvt_pk_f16_f32 v100, v104, v105
  v_cvt_pk_f16_f32 v101, v106, v107
  v_cvt_pk_f16_f32 v102, v108, v109
  v_cvt_pk_f16_f32 v103, v110, v111
  v_pk_mul_f16 v88, v80, v24
  v_pk_mul_f16 v104, v96, v24
  v_mfma_f32_32x32x16_f16 v[128:143], a[236:239], a[132:135], v[128:143]
  s_add_u32 m0, s47, 2048
  s_nop 0
  buffer_load_dwordx4 v1, s[12:15], s40 offen lds
  buffer_load_dwordx4 v2, s[12:15], s40 offen offset:1024 lds
  s_add_u32 s40, s40, s43
  s_cmp_eq_u32 s40, s42
  s_cselect_b32 s40, s41, s40
  v_pk_mul_f16 v89, v81, v25
  v_pk_mul_f16 v105, v97, v25
  v_pk_mul_f16 v90, v82, v26
  v_pk_mul_f16 v106, v98, v26
  v_pk_mul_f16 v91, v83, v27
  v_pk_mul_f16 v107, v99, v27
  v_mfma_f32_32x32x16_f16 v[112:127], a[236:239], a[140:143], v[112:127]
  v_pk_mul_f16 v92, v84, v28
  v_pk_mul_f16 v108, v100, v28
  v_pk_mul_f16 v93, v85, v29
  v_pk_mul_f16 v109, v101, v29
  v_pk_mul_f16 v94, v86, v30
  v_pk_mul_f16 v110, v102, v30
  v_mfma_f32_32x32x16_f16 v[128:143], a[228:231], a[148:151], v[128:143]
  v_pk_mul_f16 v95, v87, v31
  v_pk_mul_f16 v111, v103, v31
  v_pk_fma_f16 v88, v96, v40, v88
  v_pk_fma_f16 v104, v80, v40, v104 neg_lo:[1,0,0] neg_hi:[1,0,0]
  v_pk_fma_f16 v89, v97, v41, v89
  v_pk_fma_f16 v105, v81, v41, v105 neg_lo:[1,0,0] neg_hi:[1,0,0]
  s_waitcnt lgkmcnt(4)
  v_mfma_f32_32x32x16_f16 v[144:159], a[240:243], a[128:131], 0
  v_pk_fma_f16 v90, v98, v42, v90
  v_pk_fma_f16 v106, v82, v42, v106 neg_lo:[1,0,0] neg_hi:[1,0,0]
  v_pk_fma_f16 v91, v99, v43, v91
  v_pk_fma_f16 v107, v83, v43, v107 neg_lo:[1,0,0] neg_hi:[1,0,0]
  v_pk_fma_f16 v92, v100, v44, v92
  v_pk_fma_f16 v108, v84, v44, v108 neg_lo:[1,0,0] neg_hi:[1,0,0]
  v_mfma_f32_32x32x16_f16 v[160:175], a[248:251], a[128:131], 0
  s_add_u32 m0, s47, 4096
  s_nop 0
  buffer_load_dwordx4 v1, s[12:15], s40 offen lds
  buffer_load_dwordx4 v2, s[12:15], s40 offen offset:1024 lds
  s_add_u32 s40, s40, s43
  v_pk_fma_f16 v93, v101, v45, v93
  v_pk_fma_f16 v109, v85, v45, v109 neg_lo:[1,0,0] neg_hi:[1,0,0]
  v_pk_fma_f16 v94, v102, v46, v94
  v_pk_fma_f16 v110, v86, v46, v110 neg_lo:[1,0,0] neg_hi:[1,0,0]
  v_pk_fma_f16 v95, v103, v47, v95
  v_pk_fma_f16 v111, v87, v47, v111 neg_lo:[1,0,0] neg_hi:[1,0,0]
  v_mfma_f32_32x32x16_f16 v[144:159], a[248:251], a[136:139], v[144:159]
  v_pk_add_f16 v176, v56, v88
  v_pk_add_f16 v177, v57, v89
  v_pk_add_f16 v178, v58, v90
  v_pk_add_f16 v179, v59, v91
  v_pk_add_f16 v180, v60, v92
  v_pk_add_f16 v181, v61, v93
  v_mfma_f32_32x32x16_f16 v[160:175], a[240:243], a[144:147], v[160:175]
  v_pk_add_f16 v182, v62, v94
  v_pk_add_f16 v183, v63, v95
  v_pk_add_f16 v184, v72, v104
  v_pk_add_f16 v185, v73, v105
  v_pk_add_f16 v186, v74, v106
  v_pk_add_f16 v187, v75, v107
  ds_read_b32 v254, v7
  s_waitcnt lgkmcnt(1)
  v_mfma_f32_32x32x16_f16 v[144:159], a[244:247], a[132:135], v[144:159]
  v_pk_add_f16 v188, v76, v108
  v_pk_add_f16 v189, v77, v109
  v_pk_add_f16 v190, v78, v110
  v_pk_add_f16 v191, v79, v111
  v_pk_add_f16 v192, v56, v88 neg_lo:[0,1] neg_hi:[0,1]
  v_pk_add_f16 v193, v57, v89 neg_lo:[0,1] neg_hi:[0,1]
  v_mfma_f32_32x32x16_f16 v[160:175], a[252:255], a[132:135], v[160:175]
  s_add_u32 m0, s47, 6144
  s_nop 0
  buffer_load_dwordx4 v1, s[12:15], s40 offen lds
  buffer_load_dwordx4 v2, s[12:15], s40 offen offset:1024 lds
  s_add_u32 s40, s40, s43
  s_cmp_eq_u32 s40, s42
  s_cselect_b32 s40, s41, s40
  v_pk_add_f16 v194, v58, v90 neg_lo:[0,1] neg_hi:[0,1]
  v_pk_add_f16 v195, v59, v91 neg_lo:[0,1] neg_hi:[0,1]
  v_pk_add_f16 v196, v60, v92 neg_lo:[0,1] neg_hi:[0,1]
  v_pk_add_f16 v197, v61, v93 neg_lo:[0,1] neg_hi:[0,1]
  v_pk_add_f16 v198, v62, v94 neg_lo:[0,1] neg_hi:[0,1]
  v_pk_add_f16 v199, v63, v95 neg_lo:[0,1] neg_hi:[0,1]
  v_mfma_f32_32x32x16_f16 v[144:159], a[252:255], a[140:143], v[144:159]
  v_pk_add_f16 v200, v72, v104 neg_lo:[0,1] neg_hi:[0,1]
  v_pk_add_f16 v201, v73, v105 neg_lo:[0,1] neg_hi:[0,1]
  v_pk_add_f16 v202, v74, v106 neg_lo:[0,1] neg_hi:[0,1]
  v_pk_add_f16 v203, v75, v107 neg_lo:[0,1] neg_hi:[0,1]
  v_pk_add_f16 v204, v76, v108 neg_lo:[0,1] neg_hi:[0,1]
  v_pk_add_f16 v205, v77, v109 neg_lo:[0,1] neg_hi:[0,1]
  v_mfma_f32_32x32x16_f16 v[160:175], a[244:247], a[148:151], v[160:175]
  v_pk_add_f16 v206, v78, v110 neg_lo:[0,1] neg_hi:[0,1]
  v_pk_add_f16 v207, v79, v111 neg_lo:[0,1] neg_hi:[0,1]
  v_cvt_pk_f16_f32 v112, v112, v113
  v_cvt_pk_f16_f32 v113, v114, v115
  v_cvt_pk_f16_f32 v114, v116, v117
  v_cvt_pk_f16_f32 v115, v118, v119
  v_mfma_f32_32x32x16_f16 v[48:63], a[152:155], v[176:179], 0
  v_cvt_pk_f16_f32 v116, v120, v121
  v_cvt_pk_f16_f32 v117, v122, v123
  v_cvt_pk_f16_f32 v118, v124, v125
  v_cvt_pk_f16_f32 v119, v126, v127
  v_cvt_pk_f16_f32 v128, v128, v129
  v_cvt_pk_f16_f32 v129, v130, v131
  v_mfma_f32_32x32x16_f16 v[64:79], a[160:163], v[192:195], 0
  s_add_u32 m0, s47, 8192
  s_nop 0
  buffer_load_dwordx4 v1, s[12:15], s40 offen lds
  buffer_load_dwordx4 v2, s[12:15], s40 offen offset:1024 lds
  s_add_u32 s40, s40, s43
  v_cvt_pk_f16_f32 v130, v132, v133
  v_cvt_pk_f16_f32 v131, v134, v135
  v_cvt_pk_f16_f32 v132, v136, v137
  v_cvt_pk_f16_f32 v133, v138, v139
  v_cvt_pk_f16_f32 v134, v140, v141
  v_cvt_pk_f16_f32 v135, v142, v143
  v_mfma_f32_32x32x16_f16 v[48:63], a[156:159], v[180:183], v[48:63]
  v_pk_mul_f16 v120, v112, v16
  v_pk_mul_f16 v136, v128, v16
  v_pk_mul_f16 v121, v113, v17
  v_pk_mul_f16 v137, v129, v17
  v_pk_mul_f16 v122, v114, v18
  v_pk_mul_f16 v138, v130, v18
  v_mfma_f32_32x32x16_f16 v[64:79], a[164:167], v[196:199], v[64:79]
  v_pk_mul_f16 v123, v115, v19
  v_pk_mul_f16 v139, v131, v19
  v_pk_mul_f16 v124, v116, v20
  v_pk_mul_f16 v140, v132, v20
  v_pk_mul_f16 v125, v117, v21
  v_pk_mul_f16 v141, v133, v21
  v_mfma_f32_32x32x16_f16 v[48:63], a[168:171], v[184:187], v[48:63]
  v_pk_mul_f16 v126, v118, v22
  v_pk_mul_f16 v142, v134, v22
  v_pk_mul_f16 v127, v119, v23
  v_pk_mul_f16 v143, v135, v23
  v_pk_fma_f16 v120, v128, v32, v120
  v_pk_fma_f16 v136, v112, v32, v136 neg_lo:[1,0,0] neg_hi:[1,0,0]
  v_mfma_f32_32x32x16_f16 v[64:79], a[176:179], v[200:203], v[64:79]
  s_add_u32 m0, s47, 10240
  s_nop 0
  buffer_load_dwordx4 v1, s[12:15], s40 offen lds
  buffer_load_dwordx4 v2, s[12:15], s40 offen offset:1024 lds
  s_add_u32 s40, s40, s43
  s_cmp_eq_u32 s40, s42
  s_cselect_b32 s40, s41, s40
  v_pk_fma_f16 v121, v129, v33, v121
  v_pk_fma_f16 v137, v113, v33, v137 neg_lo:[1,0,0] neg_hi:[1,0,0]
  v_pk_fma_f16 v122, v130, v34, v122
  v_pk_fma_f16 v138, v114, v34, v138 neg_lo:[1,0,0] neg_hi:[1,0,0]
  v_pk_fma_f16 v123, v131, v35, v123
  v_pk_fma_f16 v139, v115, v35, v139 neg_lo:[1,0,0] neg_hi:[1,0,0]
  v_mfma_f32_32x32x16_f16 v[48:63], a[172:175], v[188:191], v[48:63]
  v_pk_fma_f16 v124, v132, v36, v124
  v_pk_fma_f16 v140, v116, v36, v140 neg_lo:[1,0,0] neg_hi:[1,0,0]
  v_pk_fma_f16 v125, v133, v37, v125
  v_pk_fma_f16 v141, v117, v37, v141 neg_lo:[1,0,0] neg_hi:[1,0,0]
  v_pk_fma_f16 v126, v134, v38, v126
  v_pk_fma_f16 v142, v118, v38, v142 neg_lo:[1,0,0] neg_hi:[1,0,0]
  v_mfma_f32_32x32x16_f16 v[64:79], a[180:183], v[204:207], v[64:79]
  v_pk_fma_f16 v127, v135, v39, v127
  v_pk_fma_f16 v143, v119, v39, v143 neg_lo:[1,0,0] neg_hi:[1,0,0]
  v_cvt_pk_f16_f32 v144, v144, v145
  v_cvt_pk_f16_f32 v145, v146, v147
  v_cvt_pk_f16_f32 v146, v148, v149
  v_cvt_pk_f16_f32 v147, v150, v151
  v_cvt_pk_f16_f32 v148, v152, v153
  v_cvt_pk_f16_f32 v149, v154, v155
  v_cvt_pk_f16_f32 v150, v156, v157
  v_cvt_pk_f16_f32 v151, v158, v159
  v_cvt_pk_f16_f32 v160, v160, v161
  v_cvt_pk_f16_f32 v161, v162, v163
  v_cvt_pk_f16_f32 v162, v164, v165
  v_cvt_pk_f16_f32 v163, v166, v167
  v_cvt_pk_f16_f32 v164, v168, v169
  v_cvt_pk_f16_f32 v165, v170, v171
  v_cvt_pk_f16_f32 v166, v172, v173
  v_cvt_pk_f16_f32 v167, v174, v175
  v_pk_mul_f16 v152, v144, v24
  v_pk_mul_f16 v168, v160, v24
  v_pk_mul_f16 v153, v145, v25
  v_pk_mul_f16 v169, v161, v25
  v_pk_mul_f16 v154, v146, v26
  v_pk_mul_f16 v170, v162, v26
  v_pk_mul_f16 v155, v147, v27
  v_pk_mul_f16 v171, v163, v27
  v_pk_mul_f16 v156, v148, v28
  v_pk_mul_f16 v172, v164, v28
  v_pk_mul_f16 v157, v149, v29
  v_pk_mul_f16 v173, v165, v29
  v_pk_mul_f16 v158, v150, v30
  v_pk_mul_f16 v174, v166, v30
  v_pk_mul_f16 v159, v151, v31
  v_pk_mul_f16 v175, v167, v31
  v_pk_fma_f16 v152, v160, v40, v152
  v_pk_fma_f16 v168, v144, v40, v168 neg_lo:[1,0,0] neg_hi:[1,0,0]
  v_pk_fma_f16 v153, v161, v41, v153
  v_pk_fma_f16 v169, v145, v41, v169 neg_lo:[1,0,0] neg_hi:[1,0,0]
  v_pk_fma_f16 v154, v162, v42, v154
  v_pk_fma_f16 v170, v146, v42, v170 neg_lo:[1,0,0] neg_hi:[1,0,0]
  v_pk_fma_f16 v155, v163, v43, v155
  v_pk_fma_f16 v171, v147, v43, v171 neg_lo:[1,0,0] neg_hi:[1,0,0]
  v_pk_fma_f16 v156, v164, v44, v156
  v_pk_fma_f16 v172, v148, v44, v172 neg_lo:[1,0,0] neg_hi:[1,0,0]
  v_pk_fma_f16 v157, v165, v45, v157
  v_pk_fma_f16 v173, v149, v45, v173 neg_lo:[1,0,0] neg_hi:[1,0,0]
  v_pk_fma_f16 v158, v166, v46, v158
  v_pk_fma_f16 v174, v150, v46, v174 neg_lo:[1,0,0] neg_hi:[1,0,0]
  v_pk_fma_f16 v159, v167, v47, v159
  v_pk_fma_f16 v175, v151, v47, v175 neg_lo:[1,0,0] neg_hi:[1,0,0]
  v_pk_add_f16 v176, v120, v152
  v_pk_add_f16 v177, v121, v153
  v_pk_add_f16 v178, v122, v154
  v_pk_add_f16 v179, v123, v155
  v_pk_add_f16 v180, v124, v156
  v_pk_add_f16 v181, v125, v157
  v_pk_add_f16 v182, v126, v158
  v_pk_add_f16 v183, v127, v159
  v_pk_add_f16 v184, v136, v168
  v_pk_add_f16 v185, v137, v169
  v_pk_add_f16 v186, v138, v170
  v_pk_add_f16 v187, v139, v171
  v_pk_add_f16 v188, v140, v172
  v_pk_add_f16 v189, v141, v173
  v_pk_add_f16 v190, v142, v174
  v_pk_add_f16 v191, v143, v175
  v_pk_add_f16 v192, v120, v152 neg_lo:[0,1] neg_hi:[0,1]
  v_pk_add_f16 v193, v121, v153 neg_lo:[0,1] neg_hi:[0,1]
  v_pk_add_f16 v194, v122, v154 neg_lo:[0,1] neg_hi:[0,1]
  v_pk_add_f16 v195, v123, v155 neg_lo:[0,1] neg_hi:[0,1]
  v_pk_add_f16 v196, v124, v156 neg_lo:[0,1] neg_hi:[0,1]
  v_pk_add_f16 v197, v125, v157 neg_lo:[0,1] neg_hi:[0,1]
  v_pk_add_f16 v198, v126, v158 neg_lo:[0,1] neg_hi:[0,1]
  v_pk_add_f16 v199, v127, v159 neg_lo:[0,1] neg_hi:[0,1]
  v_pk_add_f16 v200, v136, v168 neg_lo:[0,1] neg_hi:[0,1]
  v_pk_add_f16 v201, v137, v169 neg_lo:[0,1] neg_hi:[0,1]
  v_pk_add_f16 v202, v138, v170 neg_lo:[0,1] neg_hi:[0,1]
  v_pk_add_f16 v203, v139, v171 neg_lo:[0,1] neg_hi:[0,1]
  v_pk_add_f16 v204, v140, v172 neg_lo:[0,1] neg_hi:[0,1]
  v_pk_add_f16 v205, v141, v173 neg_lo:[0,1] neg_hi:[0,1]
  v_pk_add_f16 v206, v142, v174 neg_lo:[0,1] neg_hi:[0,1]
  v_pk_add_f16 v207, v143, v175 neg_lo:[0,1] neg_hi:[0,1]
  v_mfma_f32_32x32x16_f16 v[112:127], a[152:155], v[176:179], 0
  v_mfma_f32_32x32x16_f16 v[128:143], a[160:163], v[192:195], 0
  s_add_u32 m0, s47, 12288
  s_nop 0
  buffer_load_dwordx4 v1, s[12:15], s40 offen lds
  buffer_load_dwordx4 v2, s[12:15], s40 offen offset:1024 lds
  s_add_u32 s40, s40, s43
  v_mfma_f32_32x32x16_f16 v[112:127], a[156:159], v[180:183], v[112:127]
  v_mfma_f32_32x32x16_f16 v[128:143], a[164:167], v[196:199], v[128:143]
  v_mfma_f32_32x32x16_f16 v[112:127], a[168:171], v[184:187], v[112:127]
  v_mfma_f32_32x32x16_f16 v[128:143], a[176:179], v[200:203], v[128:143]
  s_add_u32 m0, s47, 14336
  s_nop 0
  buffer_load_dwordx4 v1, s[12:15], s40 offen lds
  buffer_load_dwordx4 v2, s[12:15], s40 offen offset:1024 lds
  s_add_u32 s40, s40, s43
  s_cmp_eq_u32 s40, s42
  s_cselect_b32 s40, s41, s40
  v_mfma_f32_32x32x16_f16 v[112:127], a[172:175], v[188:191], v[112:127]
  v_mfma_f32_32x32x16_f16 v[128:143], a[180:183], v[204:207], v[128:143]
  s_nop 10
  v_cvt_pk_bf16_f32 v48, v48, v112
  ds_write_b32 v244, v48 offset:0
  v_cvt_pk_bf16_f32 v49, v49, v113
  ds_write_b32 v244, v49 offset:256
  v_cvt_pk_bf16_f32 v50, v50, v114
  ds_write_b32 v244, v50 offset:512
  v_cvt_pk_bf16_f32 v51, v51, v115
  ds_write_b32 v244, v51 offset:768
  v_cvt_pk_bf16_f32 v52, v52, v116
  ds_write_b32 v244, v52 offset:2048
  v_cvt_pk_bf16_f32 v53, v53, v117
  ds_write_b32 v244, v53 offset:2304
  v_cvt_pk_bf16_f32 v54, v54, v118
  ds_write_b32 v244, v54 offset:2560
  v_cvt_pk_bf16_f32 v55, v55, v119
  ds_write_b32 v244, v55 offset:2816
  v_cvt_pk_bf16_f32 v56, v56, v120
  ds_write_b32 v244, v56 offset:4096
  v_cvt_pk_bf16_f32 v57, v57, v121
  ds_write_b32 v244, v57 offset:4352
  v_cvt_pk_bf16_f32 v58, v58, v122
  ds_write_b32 v244, v58 offset:4608
  v_cvt_pk_bf16_f32 v59, v59, v123
  ds_write_b32 v244, v59 offset:4864
  v_cvt_pk_bf16_f32 v60, v60, v124
  ds_write_b32 v244, v60 offset:6144
  v_cvt_pk_bf16_f32 v61, v61, v125
  ds_write_b32 v244, v61 offset:6400
  v_cvt_pk_bf16_f32 v62, v62, v126
  ds_write_b32 v244, v62 offset:6656
  v_cvt_pk_bf16_f32 v63, v63, v127
  ds_write_b32 v244, v63 offset:6912
  v_cvt_pk_bf16_f32 v64, v64, v128
  ds_write_b32 v244, v64 offset:128
  v_cvt_pk_bf16_f32 v65, v65, v129
  ds_write_b32 v244, v65 offset:384
  v_cvt_pk_bf16_f32 v66, v66, v130
  ds_write_b32 v244, v66 offset:640
  v_cvt_pk_bf16_f32 v67, v67, v131
  ds_write_b32 v244, v67 offset:896
  v_cvt_pk_bf16_f32 v68, v68, v132
  ds_write_b32 v244, v68 offset:2176
  v_cvt_pk_bf16_f32 v69, v69, v133
  ds_write_b32 v244, v69 offset:2432
  v_cvt_pk_bf16_f32 v70, v70, v134
  ds_write_b32 v244, v70 offset:2688
  v_cvt_pk_bf16_f32 v71, v71, v135
  ds_write_b32 v244, v71 offset:2944
  v_cvt_pk_bf16_f32 v72, v72, v136
  ds_write_b32 v244, v72 offset:4224
  v_cvt_pk_bf16_f32 v73, v73, v137
  ds_write_b32 v244, v73 offset:4480
  v_cvt_pk_bf16_f32 v74, v74, v138
  ds_write_b32 v244, v74 offset:4736
  v_cvt_pk_bf16_f32 v75, v75, v139
  ds_write_b32 v244, v75 offset:4992
  v_cvt_pk_bf16_f32 v76, v76, v140
  ds_write_b32 v244, v76 offset:6272
  v_cvt_pk_bf16_f32 v77, v77, v141
  ds_write_b32 v244, v77 offset:6528
  v_cvt_pk_bf16_f32 v78, v78, v142
  ds_write_b32 v244, v78 offset:6784
  v_cvt_pk_bf16_f32 v79, v79, v143
  ds_write_b32 v244, v79 offset:7040
  v_xor_b32 v232, 16, v240
  v_add_u32 v233, 0x10000, v232
  ds_read_b64_tr_b16 a[192:193], v232 offset:0
  ds_read_b64_tr_b16 a[194:195], v232 offset:8192
  ds_read_b64_tr_b16 a[196:197], v233 offset:0
  ds_read_b64_tr_b16 a[198:199], v233 offset:8192
  ds_read_b64_tr_b16 a[208:209], v232 offset:1024
  ds_read_b64_tr_b16 a[210:211], v232 offset:9216
  ds_read_b64_tr_b16 a[212:213], v233 offset:1024
  ds_read_b64_tr_b16 a[214:215], v233 offset:9216
  s_cmp_eq_u32 s78, 0
  s_cbranch_scc0 L_nyquist
L17_no_nyquist:
  s_lshl_b32 s50, s39, 15
  s_lshl_b32 s51, s3, 13
  s_add_u32 s50, s50, s51
  s_add_u32 s52, s50, 6291456
  s_add_u32 s53, s52, 4096
  s_waitcnt lgkmcnt(0)
  s_barrier
  ds_read2st64_b32 v[144:145], v245 offset0:0 offset1:32
  ds_read2st64_b32 v[146:147], v245 offset0:64 offset1:96
  ds_read2st64_b32 v[148:149], v245 offset0:1 offset1:33
  ds_read2st64_b32 v[150:151], v245 offset0:65 offset1:97
  ds_read2st64_b32 v[152:153], v245 offset0:2 offset1:34
  ds_read2st64_b32 v[154:155], v245 offset0:66 offset1:98
  ds_read2st64_b32 v[156:157], v245 offset0:3 offset1:35
  ds_read2st64_b32 v[158:159], v245 offset0:67 offset1:99
  ds_read2st64_b32 v[160:161], v245 offset0:4 offset1:36
  ds_read2st64_b32 v[162:163], v245 offset0:68 offset1:100
  ds_read2st64_b32 v[164:165], v245 offset0:5 offset1:37
  ds_read2st64_b32 v[166:167], v245 offset0:69 offset1:101
  ds_read2st64_b32 v[168:169], v245 offset0:6 offset1:38
  ds_read2st64_b32 v[170:171], v245 offset0:70 offset1:102
  ds_read2st64_b32 v[172:173], v245 offset0:7 offset1:39
  ds_read2st64_b32 v[174:175], v245 offset0:71 offset1:103
  s_mul_i32 s50, s38, 112
  s_mul_i32 s51, s3, 28
  s_add_u32 s50, s50, s51
  s_mul_i32 s50, s50, 16
  s_add_u32 s50, s50, 9175040
  v_min_u32 v10, 27, v0
  v_mul_u32_u24 v10, 16, v10
  v_add_u32 v10, s50, v10
  s_mov_b32 s74, 16384
  s_lshl_b32 s50, s67, 8
  v_xor_b32 v5, s50, v7
  v_add_u32 v6, 114688, v5
  s_mul_i32 s45, s38, 229376
  s_mul_i32 s50, s3, 28672
  s_add_u32 s45, s45, s50
  s_add_u32 s45, s45, 4194304
  s_add_u32 s46, s45, 28672
  s_lshl_b32 s50, s64, 10
  s_add_u32 s44, s45, s50
  s_waitcnt lgkmcnt(14)
  buffer_store_dwordx4 v[144:147], v7, s[16:19], s52 offen offset:0 sc1
  s_waitcnt lgkmcnt(12)
  buffer_store_dwordx4 v[148:151], v7, s[16:19], s52 offen offset:1024 sc1
  s_waitcnt lgkmcnt(10)
  buffer_store_dwordx4 v[152:155], v7, s[16:19], s52 offen offset:2048 sc1
  s_waitcnt lgkmcnt(8)
  buffer_store_dwordx4 v[156:159], v7, s[16:19], s52 offen offset:3072 sc1
  s_waitcnt lgkmcnt(6)
  buffer_store_dwordx4 v[160:163], v7, s[16:19], s53 offen offset:0 sc1
  s_waitcnt lgkmcnt(4)
  buffer_store_dwordx4 v[164:167], v7, s[16:19], s53 offen offset:1024 sc1
  s_waitcnt lgkmcnt(2)
  buffer_store_dwordx4 v[168:171], v7, s[16:19], s53 offen offset:2048 sc1
  s_waitcnt lgkmcnt(0)
  s_barrier
  s_add_u32 m0, s47, 16384
  s_nop 0
  buffer_load_dwordx4 v1, s[12:15], s40 offen lds
  buffer_load_dwordx4 v2, s[12:15], s40 offen offset:1024 lds
  s_add_u32 s40, s40, s43
  s_add_u32 m0, s47, 18432
  s_nop 0
  buffer_load_dwordx4 v1, s[12:15], s40 offen lds
  buffer_load_dwordx4 v2, s[12:15], s40 offen offset:1024 lds
  s_add_u32 s40, s40, s43
  s_cmp_eq_u32 s40, s42
  s_cselect_b32 s40, s41, s40
  s_mul_i32 s50, s3, 6144
  v_add_u32 v200, s50, v7
  v_add_u32 v201, s47, v7
  s_xor_b32 s50, s3, 1
  s_mul_i32 s51, s50, 6144
  v_add_u32 v202, s51, v7
  s_lshl_b32 s51, s50, 11
  v_add_u32 v205, s51, v7
  s_xor_b32 s50, s3, 2
  s_mul_i32 s51, s50, 6144
  v_add_u32 v203, s51, v7
  s_lshl_b32 s51, s50, 15
  s_add_u32 s51, s51, 32768
  v_add_u32 v206, s51, v7
  s_xor_b32 s50, s3, 3
  s_mul_i32 s51, s50, 6144
  v_add_u32 v204, s51, v7
  s_lshl_b32 s51, s50, 15
  s_add_u32 s51, s51, 32768
  v_add_u32 v207, s51, v7
  s_lshl_b32 s50, s3, 11
  v_add_u32 v223, s50, v7
  buffer_load_dword v9, v10, s[16:19], 0 offen sc1
  buffer_store_dwordx4 v[172:175], v7, s[16:19], s53 offen offset:3072 sc1
  s_branch L_join
L_nyquist:
  s_waitcnt lgkmcnt(0)
  v_mfma_f32_32x32x16_f16 v[48:63], a[192:195], a[128:131], 0
  v_mfma_f32_32x32x16_f16 v[64:79], a[192:195], a[144:147], 0
  v_mfma_f32_32x32x16_f16 v[48:63], a[196:199], a[132:135], v[48:63]
  v_mfma_f32_32x32x16_f16 v[64:79], a[196:199], a[148:151], v[64:79]
  v_mfma_f32_32x32x16_f16 v[80:95], a[208:211], a[128:131], 0
  v_mfma_f32_32x32x16_f16 v[96:111], a[208:211], a[144:147], 0
  v_mfma_f32_32x32x16_f16 v[80:95], a[212:215], a[132:135], v[80:95]
  s_nop 7
  v_cvt_pk_f16_f32 v48, v48, v49
  v_cvt_pk_f16_f32 v49, v50, v51
  v_cvt_pk_f16_f32 v50, v52, v53
  v_cvt_pk_f16_f32 v51, v54, v55
  v_cvt_pk_f16_f32 v52, v56, v57
  v_cvt_pk_f16_f32 v53, v58, v59
  v_mfma_f32_32x32x16_f16 v[96:111], a[212:215], a[148:151], v[96:111]
  v_cvt_pk_f16_f32 v54, v60, v61
  v_cvt_pk_f16_f32 v55, v62, v63
  v_cvt_pk_f16_f32 v64, v64, v65
  v_cvt_pk_f16_f32 v65, v66, v67
  v_cvt_pk_f16_f32 v66, v68, v69
  v_cvt_pk_f16_f32 v67, v70, v71
  v_cvt_pk_f16_f32 v68, v72, v73
  v_cvt_pk_f16_f32 v69, v74, v75
  v_cvt_pk_f16_f32 v70, v76, v77
  v_cvt_pk_f16_f32 v71, v78, v79
  v_pk_mul_f16 v56, v48, v16
  v_pk_mul_f16 v72, v64, v16
  v_pk_mul_f16 v57, v49, v17
  v_pk_mul_f16 v73, v65, v17
  v_pk_mul_f16 v58, v50, v18
  v_pk_mul_f16 v74, v66, v18
  v_pk_mul_f16 v59, v51, v19
  v_pk_mul_f16 v75, v67, v19
  v_pk_mul_f16 v60, v52, v20
  v_pk_mul_f16 v76, v68, v20
  v_pk_mul_f16 v61, v53, v21
  v_pk_mul_f16 v77, v69, v21
  v_pk_mul_f16 v62, v54, v22
  v_pk_mul_f16 v78, v70, v22
  v_pk_mul_f16 v63, v55, v23
  v_pk_mul_f16 v79, v71, v23
  v_pk_fma_f16 v56, v64, v32, v56
  v_pk_fma_f16 v72, v48, v32, v72 neg_lo:[1,0,0] neg_hi:[1,0,0]
  v_pk_fma_f16 v57, v65, v33, v57
  v_pk_fma_f16 v73, v49, v33, v73 neg_lo:[1,0,0] neg_hi:[1,0,0]
  v_pk_fma_f16 v58, v66, v34, v58
  v_pk_fma_f16 v74, v50, v34, v74 neg_lo:[1,0,0] neg_hi:[1,0,0]
  v_pk_fma_f16 v59, v67, v35, v59
  v_pk_fma_f16 v75, v51, v35, v75 neg_lo:[1,0,0] neg_hi:[1,0,0]
  v_pk_fma_f16 v60, v68, v36, v60
  v_pk_fma_f16 v76, v52, v36, v76 neg_lo:[1,0,0] neg_hi:[1,0,0]
  v_pk_fma_f16 v61, v69, v37, v61
  v_pk_fma_f16 v77, v53, v37, v77 neg_lo:[1,0,0] neg_hi:[1,0,0]
  v_pk_fma_f16 v62, v70, v38, v62
  v_pk_fma_f16 v78, v54, v38, v78 neg_lo:[1,0,0] neg_hi:[1,0,0]
  v_pk_fma_f16 v63, v71, v39, v63
  v_pk_fma_f16 v79, v55, v39, v79 neg_lo:[1,0,0] neg_hi:[1,0,0]
  v_cvt_pk_f16_f32 v80, v80, v81
  v_cvt_pk_f16_f32 v81, v82, v83
  v_cvt_pk_f16_f32 v82, v84, v85
  v_cvt_pk_f16_f32 v83, v86, v87
  v_cvt_pk_f16_f32 v84, v88, v89
  v_cvt_pk_f16_f32 v85, v90, v91
  v_cvt_pk_f16_f32 v86, v92, v93
  v_cvt_pk_f16_f32 v87, v94, v95
  v_cvt_pk_f16_f32 v96, v96, v97
  v_cvt_pk_f16_f32 v97, v98, v99
  v_cvt_pk_f16_f32 v98, v100, v101
  v_cvt_pk_f16_f32 v99, v102, v103
  v_cvt_pk_f16_f32 v100, v104, v105
  v_cvt_pk_f16_f32 v101, v106, v107
  v_cvt_pk_f16_f32 v102, v108, v109
  v_cvt_pk_f16_f32 v103, v110, v111
  v_pk_mul_f16 v88, v80, v24
  v_pk_mul_f16 v104, v96, v24
  v_pk_mul_f16 v89, v81, v25
  v_pk_mul_f16 v105, v97, v25
  v_pk_mul_f16 v90, v82, v26
  v_pk_mul_f16 v106, v98, v26
  v_pk_mul_f16 v91, v83, v27
  v_pk_mul_f16 v107, v99, v27
  v_pk_mul_f16 v92, v84, v28
  v_pk_mul_f16 v108, v100, v28
  v_pk_mul_f16 v93, v85, v29
  v_pk_mul_f16 v109, v101, v29
  v_pk_mul_f16 v94, v86, v30
  v_pk_mul_f16 v110, v102, v30
  v_pk_mul_f16 v95, v87, v31
  v_pk_mul_f16 v111, v103, v31
  v_pk_fma_f16 v88, v96, v40, v88
  v_pk_fma_f16 v104, v80, v40, v104 neg_lo:[1,0,0] neg_hi:[1,0,0]
  v_pk_fma_f16 v89, v97, v41, v89
  v_pk_fma_f16 v105, v81, v41, v105 neg_lo:[1,0,0] neg_hi:[1,0,0]
  v_pk_fma_f16 v90, v98, v42, v90
  v_pk_fma_f16 v106, v82, v42, v106 neg_lo:[1,0,0] neg_hi:[1,0,0]
  v_pk_fma_f16 v91, v99, v43, v91
  v_pk_fma_f16 v107, v83, v43, v107 neg_lo:[1,0,0] neg_hi:[1,0,0]
  v_pk_fma_f16 v92, v100, v44, v92
  v_pk_fma_f16 v108, v84, v44, v108 neg_lo:[1,0,0] neg_hi:[1,0,0]
  v_pk_fma_f16 v93, v101, v45, v93
  v_pk_fma_f16 v109, v85, v45, v109 neg_lo:[1,0,0] neg_hi:[1,0,0]
  v_pk_fma_f16 v94, v102, v46, v94
  v_pk_fma_f16 v110, v86, v46, v110 neg_lo:[1,0,0] neg_hi:[1,0,0]
  v_pk_fma_f16 v95, v103, v47, v95
  v_pk_fma_f16 v111, v87, v47, v111 neg_lo:[1,0,0] neg_hi:[1,0,0]
  v_pk_add_f16 v176, v56, v88
  v_pk_add_f16 v177, v57, v89
  v_pk_add_f16 v178, v58, v90
  v_pk_add_f16 v179, v59, v91
  v_pk_add_f16 v180, v60, v92
  v_pk_add_f16 v181, v61, v93
  v_pk_add_f16 v182, v62, v94
  v_pk_add_f16 v183, v63, v95
  v_pk_add_f16 v184, v72, v104
  v_pk_add_f16 v185, v73, v105
  v_pk_add_f16 v186, v74, v106
  v_pk_add_f16 v187, v75, v107
  v_pk_add_f16 v188, v76, v108
  v_pk_add_f16 v189, v77, v109
  v_pk_add_f16 v190, v78, v110
  v_pk_add_f16 v191, v79, v111
  v_pk_add_f16 v192, v56, v88 neg_lo:[0,1] neg_hi:[0,1]
  v_pk_add_f16 v193, v57, v89 neg_lo:[0,1] neg_hi:[0,1]
  v_pk_add_f16 v194, v58, v90 neg_lo:[0,1] neg_hi:[0,1]
  v_pk_add_f16 v195, v59, v91 neg_lo:[0,1] neg_hi:[0,1]
  v_pk_add_f16 v196, v60, v92 neg_lo:[0,1] neg_hi:[0,1]
  v_pk_add_f16 v197, v61, v93 neg_lo:[0,1] neg_hi:[0,1]
  v_pk_add_f16 v198, v62, v94 neg_lo:[0,1] neg_hi:[0,1]
  v_pk_add_f16 v199, v63, v95 neg_lo:[0,1] neg_hi:[0,1]
  v_pk_add_f16 v200, v72, v104 neg_lo:[0,1] neg_hi:[0,1]
  v_pk_add_f16 v201, v73, v105 neg_lo:[0,1] neg_hi:[0,1]
  v_pk_add_f16 v202, v74, v106 neg_lo:[0,1] neg_hi:[0,1]
  v_pk_add_f16 v203, v75, v107 neg_lo:[0,1] neg_hi:[0,1]
  v_pk_add_f16 v204, v76, v108 neg_lo:[0,1] neg_hi:[0,1]
  v_pk_add_f16 v205, v77, v109 neg_lo:[0,1] neg_hi:[0,1]
  v_pk_add_f16 v206, v78, v110 neg_lo:[0,1] neg_hi:[0,1]
  v_pk_add_f16 v207, v79, v111 neg_lo:[0,1] neg_hi:[0,1]
  v_mfma_f32_32x32x16_f16 v[48:63], a[152:155], v[176:179], 0
  v_mfma_f32_32x32x16_f16 v[64:79], a[160:163], v[192:195], 0
  v_mfma_f32_32x32x16_f16 v[48:63], a[156:159], v[180:183], v[48:63]
  v_mfma_f32_32x32x16_f16 v[64:79], a[164:167], v[196:199], v[64:79]
  v_mfma_f32_32x32x16_f16 v[48:63], a[168:171], v[184:187], v[48:63]
  v_mfma_f32_32x32x16_f16 v[64:79], a[176:179], v[200:203], v[64:79]
  v_mfma_f32_32x32x16_f16 v[48:63], a[172:175], v[188:191], v[48:63]
  v_mfma_f32_32x32x16_f16 v[64:79], a[180:183], v[204:207], v[64:79]
  s_mov_b32 s50, 7340032
  s_nop 9
  v_cvt_pk_bf16_f32 v176, v48, v49
  v_cvt_pk_bf16_f32 v177, v50, v51
  v_cvt_pk_bf16_f32 v178, v52, v53
  v_cvt_pk_bf16_f32 v179, v54, v55
  buffer_store_dwordx4 v[176:179], v7, s[16:19], s50 offen offset:0 sc1
  v_cvt_pk_bf16_f32 v180, v56, v57
  v_cvt_pk_bf16_f32 v181, v58, v59
  v_cvt_pk_bf16_f32 v182, v60, v61
  v_cvt_pk_bf16_f32 v183, v62, v63
  buffer_store_dwordx4 v[180:183], v7, s[16:19], s50 offen offset:1024 sc1
  v_cvt_pk_bf16_f32 v184, v64, v65
  v_cvt_pk_bf16_f32 v185, v66, v67
  v_cvt_pk_bf16_f32 v186, v68, v69
  v_cvt_pk_bf16_f32 v187, v70, v71
  buffer_store_dwordx4 v[184:187], v7, s[16:19], s50 offen offset:2048 sc1
  v_cvt_pk_bf16_f32 v188, v72, v73
  v_cvt_pk_bf16_f32 v189, v74, v75
  v_cvt_pk_bf16_f32 v190, v76, v77
  v_cvt_pk_bf16_f32 v191, v78, v79
  buffer_store_dwordx4 v[188:191], v7, s[16:19], s50 offen offset:3072 sc1
  s_nop 1
  s_branch L17_no_nyquist
L_end:
  s_endpgm
.section .rodata,"a"
.p2align 6
.amdhsa_kernel recurrent_scan__spectral_fnet__mixer_token_mlp__prompt_kernel
  .amdhsa_next_free_vgpr 512
  .amdhsa_next_free_sgpr 102
  .amdhsa_accum_offset 256
  .amdhsa_group_segment_fixed_size 0
  .amdhsa_kernarg_size 104
  .amdhsa_user_sgpr_count 2
  .amdhsa_user_sgpr_kernarg_segment_ptr 1
  .amdhsa_system_sgpr_workgroup_id_x 1
  .amdhsa_float_denorm_mode_32 3
.end_amdhsa_kernel
```
